```python
import torch

def _softmax(x, axis=-1):
    return torch.softmax(x, dim=axis)
def _gelu(x):
    return torch.nn.functional.gelu(x, approximate="tanh")
def _silu(x):
    return torch.nn.functional.silu(x)
def _sigmoid(x):
    return torch.sigmoid(x)
def _layernorm(x, axis=-1, eps=1e-5):
    m = x.mean(dim=axis, keepdim=True)
    v = x.var(dim=axis, keepdim=True, unbiased=False)
    return (x - m) / torch.sqrt(v + eps)
def _scatter_add(tgt, idx, src, axis=0):
    return tgt.clone().index_add_(axis, idx, src)
def _segment_sum(src, seg, n):
    out = torch.zeros((n,) + src.shape[1:], dtype=src.dtype)
    return out.index_add_(0, seg, src)
def _pad(x, pw):
    flat = tuple(v for pair in reversed(pw) for v in pair)
    return torch.nn.functional.pad(x, flat)

kernel_name = 'standalone__batchnorm__sampling'

def setup_inputs():

    _w = (lambda a: (lambda t: t.to(torch.bfloat16) if t.is_floating_point() else t)(torch.as_tensor(a)))
    B, S, C = 1024, 32, 576
    K = 3
    return {
        "x": _w((lambda *s: torch.randn(*s, dtype=torch.bfloat16) * 0.05)(B, S, C)),
        "w": _w((lambda *s: torch.randn(*s, dtype=torch.bfloat16) * 0.05)(K, C, C) * (1.0 / (K * C) ** 0.5)),
        "mean": _w((lambda *s: torch.randn(*s, dtype=torch.bfloat16) * 0.05)(C) * 0.1),
        "var": _w(torch.abs((lambda *s: torch.randn(*s, dtype=torch.bfloat16) * 0.05)(C)) + 0.5),
        "g": _w((lambda *s: torch.randn(*s, dtype=torch.bfloat16) * 0.05)(C) + 1.0),
        "b": _w((lambda *s: torch.randn(*s, dtype=torch.bfloat16) * 0.05)(C) * 0.1),
    }

def reference(x, w, mean, var, g, b):
    K = 3
    P = K // 2
    S = x.shape[1]
    xp = _pad(x, ((0, 0), (P, P), (0, 0)))
    y = sum(torch.einsum('bsc,cd->bsd', xp[:, k:k + S, :], w[k]) for k in range(K))
    inv_std = 1.0 / torch.sqrt(var + 1e-5)
    y = (y - mean) * (g * inv_std) + b
    return _silu(y)
```

```asm
; @launch grid=(256,1,1) block=(256,1,1) lds=139776
.amdgcn_target "amdgcn-amd-amdhsa--gfx950"
.text
.globl standalone__batchnorm__sampling_kernel
.p2align 8
.type standalone__batchnorm__sampling_kernel,@function
standalone__batchnorm__sampling_kernel:
    s_cmp_ge_u32 s2, 256
    s_cbranch_scc1 MAIN_END
    s_load_dwordx2 s[88:89], s[0:1], 8
    s_load_dwordx2 s[4:5], s[0:1], 0
    s_load_dwordx4 s[96:99], s[0:1], 16
    s_load_dwordx2 s[100:101], s[0:1], 32
    s_load_dwordx2 s[38:39], s[0:1], 40
    s_load_dwordx2 s[8:9], s[0:1], 48
    s_load_dwordx2 s[16:17], s[0:1], 64
    v_lshrrev_b32 v8, 6, v0
    v_and_b32 v9, 63, v0
    s_getpc_b64 s[44:45]
PC_BASE:
    v_readfirstlane_b32 s20, v8
    s_lshr_b32 s30, s2, 3
    s_lshl_b32 s30, s30, 2
    v_add_u32 v10, s30, v8
    v_and_b32 v20, 1, v9
    v_lshl_add_u32 v10, v20, 7, v10
    v_lshlrev_b32 v10, 7, v10
    v_min_u32 v10, CODE_END-PC_BASE-4, v10
    v_mov_b32 v141, s45
    v_add_co_u32 v140, vcc, s44, v10
    v_lshrrev_b32 v13, 3, v9
    v_and_b32 v14, 7, v9
    v_addc_co_u32 v141, vcc, 0, v141, vcc
    v_lshrrev_b32 v15, 4, v9
    global_load_dword v136, v[140:141], off
    v_and_b32 v16, 200, v0
    v_and_b32 v33, 8, v9
    v_mad_u32_u24 v16, v33, 3, v16
    v_add_u32 v16, v16, v15
    v_mul_u32_u24 v16, 1152, v16
    v_lshl_add_u32 v7, v14, 4, v16
    s_lshr_b32 s27, s2, 4
    s_and_b32 s30, s2, 7
    s_lshl3_add_u32 s3, s27, s30
    s_mul_i32 s3, s3, 294912
    s_mov_b32 s6, 294912
    s_mov_b32 s7, 131072
    s_mov_b32 s91, 131072
    s_mov_b32 s45, 4608
    s_mov_b32 s46, 9216
    s_mov_b32 s47, 13824
    s_mov_b32 s48, 18432
    s_mov_b32 s49, 23040
    s_mov_b32 s50, 27648
    s_mov_b32 s51, 32256
    s_mul_i32 s33, s2, 3641
    s_lshr_b32 s33, s33, 16
    s_mul_i32 s34, s33, 18
    s_sub_u32 s34, s2, s34
    s_min_u32 s33, s33, 8
    v_and_b32 v10, 35, v9
    v_bfe_u32 v11, v9, 2, 2
    v_bfe_u32 v12, v9, 4, 1
    v_lshl_add_u32 v10, v11, 3, v10
    v_lshl_add_u32 v10, v12, 2, v10
    s_lshl_b32 s30, s33, 7
    v_lshl_add_u32 v240, v10, 1, s30
    s_mul_i32 s31, s34, 36864
    s_add_u32 s30, s30, s31
    v_lshrrev_b32 v241, 3, v0
    v_mul_u32_u24 v241, 1152, v241
    v_lshl_add_u32 v17, v14, 4, s30
    v_add_u32 v241, v241, v17
    s_mul_i32 s21, s20, 3072
    s_add_u32 s21, s21, 122880
    s_mov_b32 m0, s21
    s_cmp_lt_u32 s2, 162
    s_cselect_b32 s90, 1990656, 0
    s_cselect_b32 s94, 3981312, 0
    s_mov_b32 s31, 662528
    s_mov_b32 s35, 1325056
    v_mov_b32 v246, 0
    v_mov_b32 v247, 0
    v_mov_b32 v255, v0
    s_bfe_u32 s32, s2, 65539
    s_mul_i32 s30, s32, 576
    v_min_u32 v243, 143, v255
    v_lshl_add_u32 v244, v243, 2, s30
    s_waitcnt lgkmcnt(0)
    s_add_u32 s4, s4, s3
    s_addc_u32 s5, s5, 0
    global_load_short_d16_hi v246, v240, s[98:99]
    global_load_short_d16_hi v247, v240, s[100:101]
    buffer_load_dwordx4 v241, s[88:91], 0 offen offset:0 lds
    buffer_load_dwordx4 v241, s[88:91], s31 offen offset:1024 lds
    buffer_load_dwordx4 v241, s[88:91], s35 offen offset:2048 lds
    s_load_dwordx2 s[36:37], s[16:17], 32768
    buffer_load_dwordx4 a[32:35], v7, s[4:7], 0 offen offset:0
    buffer_load_dwordx4 a[36:39], v7, s[4:7], s45 offen offset:0
    buffer_load_dwordx4 a[40:43], v7, s[4:7], s46 offen offset:0
    buffer_load_dwordx4 a[44:47], v7, s[4:7], s47 offen offset:0
    global_load_dword v88, v244, s[96:97]
    global_load_dword v89, v244, s[98:99]
    global_load_dword v90, v244, s[100:101]
    global_load_dword v91, v244, s[38:39]
    s_mov_b32 s11, 131072
    s_mov_b32 s15, 131072
    s_mov_b32 s19, 131072
    s_mov_b32 s95, 131072
    s_add_u32 s3, s3, s30
    s_add_u32 s8, s8, s3
    s_addc_u32 s9, s9, 0
    s_sub_u32 s10, 294912, s30
    s_add_u32 s92, s16, 131072
    s_addc_u32 s93, s17, 0
    v_lshlrev_b32 v0, 4, v9
    s_mov_b32 s14, 497664
    s_lshl2_add_u32 s31, s32, s20
    s_mul_i32 s31, s31, 497664
    s_add_u32 s12, s92, s31
    s_addc_u32 s13, s93, 0
    s_mov_b32 s18, 40960
    s_mov_b32 s28, 3216550459
    s_mov_b32 s29, 4294901760
    s_mov_b32 s24, 67108864
    v_and_b32 v18, 15, v9
    v_lshrrev_b32 v34, 5, v9
    s_lshl_b32 s30, s33, 1
    v_add_u32 v19, s30, v34
    v_cmp_lt_u32 vcc, 8, v19
    v_add_u32 v21, 27, v19
    v_and_b32 v22, 3, v9
    v_cndmask_b32 v19, v19, v21, vcc
    v_lshl_add_u32 v19, v19, 1, v12
    v_mul_u32_u24 v19, 27648, v19
    v_lshl_add_u32 v21, v8, 4, v18
    v_lshl_add_u32 v245, v21, 4, v19
    v_lshl_add_u32 v21, v11, 1, v34
    v_lshl_add_u32 v21, v21, 2, v22
    v_lshl_add_u32 v21, v21, 1, v12
    v_lshl_add_u32 v242, v21, 3, s21
    s_lshl_b32 s53, s34, 10
    s_xor_b32 s54, s53, 1024
    s_add_u32 s54, s54, 497664
    s_add_u32 s55, s53, 995328
    s_add_u32 s56, s54, 995328
    s_and_b32 s30, s34, 1
    s_mul_i32 s30, s30, 497664
    s_lshr_b32 s31, s34, 1
    s_lshl_b32 s31, s31, 10
    s_add_u32 s30, s30, s31
    s_add_u32 s52, s30, 18432
    s_add_u32 s57, s52, 995328
    s_mul_i32 s30, s20, 4352
    v_lshl_add_u32 v21, v34, 4, v18
    v_lshl_add_u32 v21, v21, 4, s30
    v_xor_b32 v23, v11, v12
    v_and_b32 v23, 1, v23
    v_mul_u32_u24 v23, 17408, v23
    v_add_u32 v82, v21, v23
    v_mul_u32_u24 v23, 544, v34
    v_sub_u32 v23, 34816, v23
    v_lshl_add_u32 v23, v12, 3, v23
    v_add_u32 v83, v21, v23
    s_lshr_b32 s30, s20, 1
    s_lshl_b32 s30, s30, 8
    s_and_b32 s31, s20, 1
    s_lshl_b32 s31, s31, 6
    s_add_u32 s30, s30, s31
    v_bfe_u32 v24, v9, 1, 3
    v_mul_u32_u24 v21, 544, v24
    v_lshl_add_u32 v23, v20, 3, v15
    v_lshl_add_u32 v21, v23, 4, v21
    s_xor_b32 s31, s30, 64
    v_add_u32 v85, s30, v21
    v_add_u32 v5, 65536, v85
    v_add_u32 v86, s31, v21
    v_add_u32 v6, 65536, v86
    s_mov_b32 s96, 4042264335
    s_mov_b32 s97, 4042264335
    s_mov_b32 s98, 252702960
    s_mov_b32 s99, 252702960
    v_lshlrev_b32 v26, 4, v15
    v_lshlrev_b32 v27, 4, v20
    s_mov_b32 s40, 3222323124
    s_mov_b32 s41, 1065369376
    v_lshrrev_b64 v[28:29], v26, s[40:41]
    s_mov_b32 s40, 3200827158
    s_mov_b32 s41, 1065369536
    v_lshrrev_b64 v[30:31], v26, s[40:41]
    s_mov_b32 vcc_lo, 4278255360
    s_mov_b32 vcc_hi, 4278255360
    v_cndmask_b32 v36, v28, v30, vcc
    s_mov_b32 s40, 0
    s_mov_b32 s41, 1063321600
    v_lshrrev_b64 v[28:29], v26, s[40:41]
    s_mov_b32 s40, 16225
    s_mov_b32 s41, 49193
    v_lshrrev_b64 v[30:31], v26, s[40:41]
    v_cndmask_b32 v37, v28, v30, vcc
    s_mov_b32 s40, 3223912448
    s_mov_b32 s41, 1065353216
    v_lshrrev_b64 v[28:29], v26, s[40:41]
    s_mov_b32 s40, 16256
    s_mov_b32 s41, 0
    v_lshrrev_b64 v[30:31], v26, s[40:41]
    v_cndmask_b32 v38, v28, v30, vcc
    s_mov_b32 vcc_lo, 61680
    s_mov_b32 vcc_hi, 61680
    v_xor_b32 v28, 32768, v36
    v_cndmask_b32 v36, v36, v28, vcc
    v_and_b32 v36, 65535, v36
    v_lshlrev_b32 v36, v27, v36
    v_and_b32 v37, 65535, v37
    v_lshlrev_b32 v37, v27, v37
    v_and_b32 v38, 65535, v38
    v_lshlrev_b32 v38, v27, v38
    s_mov_b32 vcc_lo, 858993459
    s_mov_b32 vcc_hi, 858993459
    v_cndmask_b32 v72, 0, v36, vcc
    v_xor_b32 v73, v72, v36
    s_mov_b32 vcc_lo, 50529027
    s_mov_b32 vcc_hi, 50529027
    v_cndmask_b32 v74, 0, v37, vcc
    v_cndmask_b32 v78, 0, v38, vcc
    s_mov_b32 vcc_lo, 202116108
    s_mov_b32 vcc_hi, 202116108
    v_cndmask_b32 v75, 0, v37, vcc
    v_cndmask_b32 v79, 0, v38, vcc
    s_mov_b32 vcc_lo, 808464432
    s_mov_b32 vcc_hi, 808464432
    v_cndmask_b32 v76, 0, v37, vcc
    v_cndmask_b32 v80, 0, v38, vcc
    s_mov_b32 vcc_lo, 3233857728
    s_mov_b32 vcc_hi, 3233857728
    v_cndmask_b32 v77, 0, v37, vcc
    v_cndmask_b32 v81, 0, v38, vcc
    v_bfe_u32 v26, v18, 1, 2
    v_xor_b32 v26, v26, v15
    v_lshl_add_u32 v26, v18, 2, v26
    s_lshl_b32 s30, s20, 11
    v_lshl_add_u32 v2, v26, 4, s30
    v_and_b32 v23, 3, v13
    v_xor_b32 v26, v23, v9
    s_lshl_b32 s30, s20, 13
    v_lshl_add_u32 v3, v26, 4, s30
    v_and_b32 v26, 4, v9
    v_lshl_add_u32 v26, v26, 1, v13
    v_lshl_add_u32 v26, v8, 4, v26
    v_mul_u32_u24 v26, 4608, v26
    v_lshl_add_u32 v1, v22, 4, v26
    s_mov_b32 s40, 1985229328
    s_mov_b32 s41, 248
    s_mul_i32 s30, s27, 86
    s_lshr_b32 s30, s30, 8
    s_mul_i32 s30, s30, 3
    s_sub_u32 s27, s27, s30
    s_cmp_eq_u32 s27, 1
    s_cselect_b32 s40, 2268413985, s40
    s_cselect_b32 s41, 246, s41
    s_cmp_eq_u32 s27, 2
    s_cselect_b32 s40, 1749242114, s40
    s_cselect_b32 s41, 247, s41
    s_and_b32 s25, s40, 15
    s_mul_i32 s22, s25, 55296
    s_mul_i32 s30, s20, 1152
    s_lshl_b32 s31, s25, 7
    s_add_u32 s30, s30, s31
    s_add_u32 s30, s30, 135168
    v_lshl_add_u32 v4, v15, 5, s30
    v_lshlrev_b32 v243, 3, v243
    v_add_u32 v92, 135168, v243
    v_mov_b32 v27, 67108864
    s_lshl_b32 s30, s2, 7
    v_mov_b32 v26, s30
    s_and_b32 s30, s30, 8064
    s_add_u32 s30, s30, 32768
    v_mov_b32 v28, s30
    v_cmp_eq_u32 vcc, 0, v255
    s_mul_i32 s30, s32, 9
    s_add_u32 s30, s30, s25
    v_cndmask_b32 v49, v27, v26, vcc
    v_cndmask_b32 v87, v27, v28, vcc
    s_lshr_b32 s30, s30, 1
    s_mul_i32 s30, s30, 2304
    s_cmp_eq_u32 s2, 255
    s_cselect_b32 s30, 0, s30
    s_cselect_b32 s31, 256, 18
    s_cselect_b32 s58, 64, 0
    v_lshl_add_u32 v26, v9, 2, v8
    v_cmp_gt_u32 vcc, s31, v26
    v_lshl_add_u32 v26, v26, 7, s30
    v_lshlrev_b32 v28, 7, v255
    v_cndmask_b32 v48, v27, v26, vcc
    s_mov_b64 s[42:43], vcc
    v_cmp_gt_u32 vcc, s58, v255
    v_add_u32 v28, 32768, v28
    s_nop 0
    v_cndmask_b32 v50, v27, v28, vcc
    buffer_load_dwordx4 a[48:51], v7, s[4:7], s48 offen offset:0
    buffer_load_dwordx4 a[52:55], v7, s[4:7], s49 offen offset:0
    buffer_load_dwordx4 a[56:59], v7, s[4:7], s50 offen offset:0
    buffer_load_dwordx4 a[60:63], v7, s[4:7], s51 offen offset:0
    s_waitcnt lgkmcnt(0)
    s_add_u32 s36, s36, 1
    s_addc_u32 s37, s37, 0
    s_mov_b32 s35, 100000
    v_mov_b32 v46, s36
    v_mov_b32 v47, s37
    s_waitcnt vmcnt(12)
    ds_read_b64_tr_b16 v[216:217], v242 offset:0
    ds_read_b64_tr_b16 v[218:219], v242 offset:512
    ds_read_b64_tr_b16 v[220:221], v242 offset:1024
    ds_read_b64_tr_b16 v[222:223], v242 offset:1536
    ds_read_b64_tr_b16 v[224:225], v242 offset:2048
    ds_read_b64_tr_b16 v[226:227], v242 offset:2560
    v_add_f32 v246, 925353388, v246
    v_cvt_pk_bf16_f32 v246, v246, v246
    v_and_b32 v246, s29, v246
    v_sqrt_f32 v246, v246
    s_nop 0
    v_cvt_pk_bf16_f32 v246, v246, v246
    v_and_b32 v246, s29, v246
    v_rcp_f32 v246, v246
    s_nop 0
    v_cvt_pk_bf16_f32 v246, v246, v246
    v_and_b32 v246, s29, v246
    v_mul_f32 v246, v247, v246
    v_cvt_pk_bf16_f32 v246, v246, v246
    v_and_b32 v246, s29, v246
    v_mul_f32 v247, 1058989997, v246
    v_mul_f32 v248, 1053204888, v246
    v_mul_f32 v249, 1048070654, v246
    v_mul_f32 v250, 3200688536, v246
    v_mul_f32 v251, 3205822770, v246
    v_mul_f32 v252, 3210704331, v246
    v_mul_f32 v253, 3218217874, v246
    v_mul_f32 v246, 3216550459, v246
    s_waitcnt lgkmcnt(5)
    v_lshlrev_b32 v160, 16, v216
    v_and_b32 v161, s29, v216
    v_lshlrev_b32 v162, 16, v217
    v_and_b32 v163, s29, v217
    s_waitcnt lgkmcnt(4)
    v_lshlrev_b32 v164, 16, v218
    v_and_b32 v165, s29, v218
    v_lshlrev_b32 v166, 16, v219
    v_and_b32 v167, s29, v219
    s_waitcnt lgkmcnt(3)
    v_lshlrev_b32 v168, 16, v220
    v_and_b32 v169, s29, v220
    v_lshlrev_b32 v170, 16, v221
    v_and_b32 v171, s29, v221
    s_waitcnt lgkmcnt(2)
    v_lshlrev_b32 v172, 16, v222
    v_and_b32 v173, s29, v222
    v_lshlrev_b32 v174, 16, v223
    v_and_b32 v175, s29, v223
    s_waitcnt lgkmcnt(1)
    v_lshlrev_b32 v176, 16, v224
    v_and_b32 v177, s29, v224
    v_lshlrev_b32 v178, 16, v225
    v_and_b32 v179, s29, v225
    s_waitcnt lgkmcnt(0)
    v_lshlrev_b32 v180, 16, v226
    v_and_b32 v181, s29, v226
    v_lshlrev_b32 v182, 16, v227
    v_and_b32 v183, s29, v227
    v_pk_mul_f32 v[184:185], v[246:247], v[160:161] op_sel:[1,0] op_sel_hi:[1,1]
    v_pk_mul_f32 v[186:187], v[246:247], v[162:163] op_sel:[1,0] op_sel_hi:[1,1]
    v_pk_mul_f32 v[188:189], v[246:247], v[164:165] op_sel:[1,0] op_sel_hi:[1,1]
    v_pk_mul_f32 v[190:191], v[246:247], v[166:167] op_sel:[1,0] op_sel_hi:[1,1]
    v_pk_fma_f32 v[184:185], v[248:249], v[176:177], v[184:185] op_sel:[1,0,0] op_sel_hi:[1,1,1]
    v_pk_fma_f32 v[186:187], v[248:249], v[178:179], v[186:187] op_sel:[1,0,0] op_sel_hi:[1,1,1]
    v_pk_fma_f32 v[188:189], v[248:249], v[180:181], v[188:189] op_sel:[1,0,0] op_sel_hi:[1,1,1]
    v_pk_fma_f32 v[190:191], v[248:249], v[182:183], v[190:191] op_sel:[1,0,0] op_sel_hi:[1,1,1]
    v_pk_fma_f32 v[192:193], v[248:249], v[168:169], v[184:185] op_sel:[0,0,0] op_sel_hi:[0,1,1] neg_lo:[1,0,0] neg_hi:[1,0,0]
    v_pk_fma_f32 v[194:195], v[248:249], v[170:171], v[186:187] op_sel:[0,0,0] op_sel_hi:[0,1,1] neg_lo:[1,0,0] neg_hi:[1,0,0]
    v_pk_fma_f32 v[196:197], v[248:249], v[172:173], v[188:189] op_sel:[0,0,0] op_sel_hi:[0,1,1] neg_lo:[1,0,0] neg_hi:[1,0,0]
    v_pk_fma_f32 v[198:199], v[248:249], v[174:175], v[190:191] op_sel:[0,0,0] op_sel_hi:[0,1,1] neg_lo:[1,0,0] neg_hi:[1,0,0]
    v_pk_fma_f32 v[184:185], v[248:249], v[168:169], v[184:185] op_sel:[0,0,0] op_sel_hi:[0,1,1]
    v_pk_fma_f32 v[186:187], v[248:249], v[170:171], v[186:187] op_sel:[0,0,0] op_sel_hi:[0,1,1]
    v_pk_fma_f32 v[188:189], v[248:249], v[172:173], v[188:189] op_sel:[0,0,0] op_sel_hi:[0,1,1]
    v_pk_fma_f32 v[190:191], v[248:249], v[174:175], v[190:191] op_sel:[0,0,0] op_sel_hi:[0,1,1]
    v_cvt_pk_bf16_f32 v224, v192, v193
    v_cvt_pk_bf16_f32 v225, v194, v195
    v_cvt_pk_bf16_f32 v226, v196, v197
    v_cvt_pk_bf16_f32 v227, v198, v199
    buffer_store_dwordx4 v[224:227], v245, s[92:95], s54 offen offset:0 sc0 sc1
    v_cvt_pk_bf16_f32 v220, v184, v185
    v_cvt_pk_bf16_f32 v221, v186, v187
    v_cvt_pk_bf16_f32 v222, v188, v189
    v_cvt_pk_bf16_f32 v223, v190, v191
    buffer_store_dwordx4 v[220:223], v245, s[92:95], s53 offen offset:0 sc0 sc1
    v_pk_mul_f32 v[200:201], v[250:251], v[160:161] op_sel:[0,0] op_sel_hi:[0,1]
    v_pk_mul_f32 v[202:203], v[250:251], v[162:163] op_sel:[0,0] op_sel_hi:[0,1]
    v_pk_mul_f32 v[204:205], v[250:251], v[164:165] op_sel:[0,0] op_sel_hi:[0,1]
    v_pk_mul_f32 v[206:207], v[250:251], v[166:167] op_sel:[0,0] op_sel_hi:[0,1]
    v_pk_fma_f32 v[200:201], v[252:253], v[176:177], v[200:201] op_sel:[0,0,0] op_sel_hi:[0,1,1]
    v_pk_fma_f32 v[202:203], v[252:253], v[178:179], v[202:203] op_sel:[0,0,0] op_sel_hi:[0,1,1]
    v_pk_fma_f32 v[204:205], v[252:253], v[180:181], v[204:205] op_sel:[0,0,0] op_sel_hi:[0,1,1]
    v_pk_fma_f32 v[206:207], v[252:253], v[182:183], v[206:207] op_sel:[0,0,0] op_sel_hi:[0,1,1]
    v_pk_fma_f32 v[208:209], v[250:251], v[168:169], v[200:201] op_sel:[1,0,0] op_sel_hi:[1,1,1] neg_lo:[1,0,0] neg_hi:[1,0,0]
    v_pk_fma_f32 v[210:211], v[250:251], v[170:171], v[202:203] op_sel:[1,0,0] op_sel_hi:[1,1,1] neg_lo:[1,0,0] neg_hi:[1,0,0]
    v_pk_fma_f32 v[212:213], v[250:251], v[172:173], v[204:205] op_sel:[1,0,0] op_sel_hi:[1,1,1] neg_lo:[1,0,0] neg_hi:[1,0,0]
    v_pk_fma_f32 v[214:215], v[250:251], v[174:175], v[206:207] op_sel:[1,0,0] op_sel_hi:[1,1,1] neg_lo:[1,0,0] neg_hi:[1,0,0]
    v_pk_fma_f32 v[200:201], v[250:251], v[168:169], v[200:201] op_sel:[1,0,0] op_sel_hi:[1,1,1]
    v_pk_fma_f32 v[202:203], v[250:251], v[170:171], v[202:203] op_sel:[1,0,0] op_sel_hi:[1,1,1]
    v_pk_fma_f32 v[204:205], v[250:251], v[172:173], v[204:205] op_sel:[1,0,0] op_sel_hi:[1,1,1]
    v_pk_fma_f32 v[206:207], v[250:251], v[174:175], v[206:207] op_sel:[1,0,0] op_sel_hi:[1,1,1]
    v_cvt_pk_bf16_f32 v232, v208, v209
    v_cvt_pk_bf16_f32 v233, v210, v211
    v_cvt_pk_bf16_f32 v234, v212, v213
    v_cvt_pk_bf16_f32 v235, v214, v215
    buffer_store_dwordx4 v[232:235], v245, s[92:95], s56 offen offset:0 sc0 sc1
    v_cvt_pk_bf16_f32 v228, v200, v201
    v_cvt_pk_bf16_f32 v229, v202, v203
    v_cvt_pk_bf16_f32 v230, v204, v205
    v_cvt_pk_bf16_f32 v231, v206, v207
    buffer_store_dwordx4 v[228:231], v245, s[92:95], s55 offen offset:0 sc0 sc1
    v_pk_mul_f32 v[160:161], v[252:253], v[160:161] op_sel:[1,0] op_sel_hi:[1,1]
    v_pk_mul_f32 v[162:163], v[252:253], v[162:163] op_sel:[1,0] op_sel_hi:[1,1]
    v_pk_mul_f32 v[164:165], v[252:253], v[164:165] op_sel:[1,0] op_sel_hi:[1,1]
    v_pk_mul_f32 v[166:167], v[252:253], v[166:167] op_sel:[1,0] op_sel_hi:[1,1]
    v_pk_mul_f32 v[176:177], v[246:247], v[176:177] op_sel:[0,0] op_sel_hi:[0,1]
    v_pk_mul_f32 v[178:179], v[246:247], v[178:179] op_sel:[0,0] op_sel_hi:[0,1]
    v_pk_mul_f32 v[180:181], v[246:247], v[180:181] op_sel:[0,0] op_sel_hi:[0,1]
    v_pk_mul_f32 v[182:183], v[246:247], v[182:183] op_sel:[0,0] op_sel_hi:[0,1]
    v_cvt_pk_bf16_f32 v216, v160, v161
    v_cvt_pk_bf16_f32 v217, v162, v163
    v_cvt_pk_bf16_f32 v218, v164, v165
    v_cvt_pk_bf16_f32 v219, v166, v167
    buffer_store_dwordx4 v[216:219], v245, s[92:95], s52 offen offset:0 sc0 sc1
    v_cvt_pk_bf16_f32 v236, v176, v177
    v_cvt_pk_bf16_f32 v237, v178, v179
    v_cvt_pk_bf16_f32 v238, v180, v181
    v_cvt_pk_bf16_f32 v239, v182, v183
    buffer_store_dwordx4 v[236:239], v245, s[92:95], s57 offen offset:0 sc0 sc1
    s_mov_b32 s52, 1050761268
    s_mov_b32 s53, 1067362987
    s_mov_b32 s54, 1059760811
    s_mov_b32 s55, 1051466193
    s_mov_b32 s56, 1068056212
    s_mov_b32 s57, 1059061760
    s_waitcnt vmcnt(17)
    v_mfma_f32_16x16x16_bf16 v[60:63], v[72:73], a[32:33], 0
    v_mfma_f32_16x16x16_bf16 v[8:11], v[72:73], a[34:35], 0
    s_waitcnt vmcnt(16)
    buffer_load_dwordx4 a[76:79], v7, s[4:7], 0 offen offset:128
    v_mfma_f32_16x16x16_bf16 v[12:15], v[72:73], a[36:37], 0
    v_mfma_f32_16x16x16_bf16 v[52:55], v[72:73], a[38:39], 0
    s_waitcnt vmcnt(16)
    buffer_load_dwordx4 a[80:83], v7, s[4:7], s45 offen offset:128
    s_nop 0
    v_cvt_pk_bf16_f32 v16, v60, v61
    v_cvt_pk_bf16_f32 v17, v62, v63
    v_mfma_f32_16x16x16_bf16 v[56:59], v[72:73], a[40:41], 0
    v_cvt_pk_bf16_f32 v18, v8, v9
    v_cvt_pk_bf16_f32 v19, v10, v11
    v_mfma_f32_16x16x16_bf16 v[60:63], v[72:73], a[42:43], 0
    s_waitcnt vmcnt(16)
    buffer_load_dwordx4 a[84:87], v7, s[4:7], s46 offen offset:128
    v_cvt_pk_bf16_f32 v20, v12, v13
    v_cvt_pk_bf16_f32 v21, v14, v15
    v_mfma_f32_16x16x16_bf16 v[8:11], v[72:73], a[44:45], 0
    s_barrier
    ds_write_b128 v82, v[16:19] offset:0
    v_cvt_pk_bf16_f32 v22, v52, v53
    v_cvt_pk_bf16_f32 v23, v54, v55
    v_mfma_f32_16x16x16_bf16 v[12:15], v[72:73], a[46:47], 0
    s_waitcnt vmcnt(12)
    buffer_load_dwordx4 a[88:91], v7, s[4:7], s47 offen offset:128
    ds_write_b128 v82, v[20:23] offset:544
    v_cvt_pk_bf16_f32 v64, v56, v57
    v_cvt_pk_bf16_f32 v65, v58, v59
    v_mfma_f32_16x16x16_bf16 v[52:55], v[72:73], a[48:49], 0
    v_cvt_pk_bf16_f32 v66, v60, v61
    v_cvt_pk_bf16_f32 v67, v62, v63
    v_mfma_f32_16x16x16_bf16 v[56:59], v[72:73], a[50:51], 0
    s_waitcnt vmcnt(12)
    buffer_load_dwordx4 a[92:95], v7, s[4:7], s48 offen offset:128
    ds_write_b128 v82, v[64:67] offset:1088
    v_cvt_pk_bf16_f32 v68, v8, v9
    v_cvt_pk_bf16_f32 v69, v10, v11
    v_mfma_f32_16x16x16_bf16 v[60:63], v[72:73], a[52:53], 0
    v_cvt_pk_bf16_f32 v70, v12, v13
    v_cvt_pk_bf16_f32 v71, v14, v15
    v_mfma_f32_16x16x16_bf16 v[8:11], v[72:73], a[54:55], 0
    s_waitcnt vmcnt(12)
    buffer_load_dwordx4 a[96:99], v7, s[4:7], s49 offen offset:128
    ds_write_b128 v82, v[68:71] offset:1632
    v_cvt_pk_bf16_f32 v16, v52, v53
    v_cvt_pk_bf16_f32 v17, v54, v55
    v_mfma_f32_16x16x16_bf16 v[12:15], v[72:73], a[56:57], 0
    v_cvt_pk_bf16_f32 v18, v56, v57
    v_cvt_pk_bf16_f32 v19, v58, v59
    v_mfma_f32_16x16x16_bf16 v[52:55], v[72:73], a[58:59], 0
    s_waitcnt vmcnt(12)
    buffer_load_dwordx4 a[100:103], v7, s[4:7], s50 offen offset:128
    ds_write_b128 v82, v[16:19] offset:2176
    v_cvt_pk_bf16_f32 v20, v60, v61
    v_cvt_pk_bf16_f32 v21, v62, v63
    v_mfma_f32_16x16x16_bf16 v[56:59], v[72:73], a[60:61], 0
    v_cvt_pk_bf16_f32 v22, v8, v9
    v_cvt_pk_bf16_f32 v23, v10, v11
    v_mfma_f32_16x16x16_bf16 v[60:63], v[72:73], a[62:63], 0
    buffer_load_dwordx4 a[104:107], v7, s[4:7], s51 offen offset:128
    ds_write_b128 v82, v[20:23] offset:2720
    v_cvt_pk_bf16_f32 v64, v12, v13
    v_cvt_pk_bf16_f32 v65, v14, v15
    v_mfma_f32_16x16x32_bf16 v[8:11], v[74:77], a[32:35], 0
    v_cvt_pk_bf16_f32 v66, v52, v53
    v_cvt_pk_bf16_f32 v67, v54, v55
    v_mfma_f32_16x16x32_bf16 v[8:11], v[78:81], a[36:39], v[8:11]
    ds_write_b128 v82, v[64:67] offset:3264
    v_cvt_pk_bf16_f32 v68, v56, v57
    v_cvt_pk_bf16_f32 v69, v58, v59
    v_mfma_f32_16x16x32_bf16 v[12:15], v[74:77], a[36:39], 0
    buffer_load_dwordx4 a[116:119], v7, s[4:7], 0 offen offset:256
    v_cvt_pk_bf16_f32 v70, v60, v61
    v_cvt_pk_bf16_f32 v71, v62, v63
    v_mfma_f32_16x16x32_bf16 v[12:15], v[78:81], a[40:43], v[12:15]
    ds_write_b128 v82, v[68:71] offset:3808
    v_mfma_f32_16x16x32_bf16 v[52:55], v[74:77], a[40:43], 0
    v_cvt_pk_bf16_f32 v16, v8, v9
    v_cvt_pk_bf16_f32 v17, v10, v11
    v_mfma_f32_16x16x32_bf16 v[52:55], v[78:81], a[44:47], v[52:55]
    buffer_load_dwordx4 a[120:123], v7, s[4:7], s45 offen offset:256
    s_cmp_eq_u32 s20, 0
    s_cselect_b64 s[100:101], -1, 0
    v_add_u32 v84, 78592, v83
    v_cndmask_b32 v84, v83, v84, s[100:101]
    v_mfma_f32_16x16x32_bf16 v[56:59], v[74:77], a[44:47], 0
    s_waitcnt lgkmcnt(0)
    s_barrier
    ds_write_b64 v84, v[16:17] offset:544
    v_cvt_pk_bf16_f32 v18, v12, v13
    v_cvt_pk_bf16_f32 v19, v14, v15
    v_mfma_f32_16x16x32_bf16 v[56:59], v[78:81], a[48:51], v[56:59]
    ds_read_b128 a[0:3], v85 offset:0
    buffer_load_dwordx4 a[124:127], v7, s[4:7], s46 offen offset:256
    ds_write_b64 v84, v[18:19] offset:1088
    v_mfma_f32_16x16x32_bf16 v[60:63], v[74:77], a[48:51], 0
    ds_read_b128 a[4:7], v86 offset:17408
    v_cvt_pk_bf16_f32 v20, v52, v53
    v_cvt_pk_bf16_f32 v21, v54, v55
    v_mfma_f32_16x16x32_bf16 v[60:63], v[78:81], a[52:55], v[60:63]
    ds_read_b128 a[8:11], v85 offset:4352
    ds_write_b64 v84, v[20:21] offset:1632
    v_mfma_f32_16x16x32_bf16 v[8:11], v[74:77], a[52:55], 0
    ds_read_b128 a[12:15], v86 offset:21760
    buffer_load_dwordx4 a[128:131], v7, s[4:7], s47 offen offset:256
    v_cvt_pk_bf16_f32 v22, v56, v57
    v_cvt_pk_bf16_f32 v23, v58, v59
    v_mfma_f32_16x16x32_bf16 v[8:11], v[78:81], a[56:59], v[8:11]
    ds_read_b128 a[16:19], v85 offset:8704
    ds_write_b64 v84, v[22:23] offset:2176
    v_mfma_f32_16x16x32_bf16 v[12:15], v[74:77], a[56:59], 0
    ds_read_b128 a[20:23], v86 offset:26112
    v_cvt_pk_bf16_f32 v64, v60, v61
    v_cvt_pk_bf16_f32 v65, v62, v63
    v_mfma_f32_16x16x32_bf16 v[12:15], v[78:81], a[60:63], v[12:15]
    ds_read_b128 a[24:27], v85 offset:13056
    buffer_load_dwordx4 a[132:135], v7, s[4:7], s48 offen offset:256
    ds_write_b64 v84, v[64:65] offset:2720
    v_mfma_f32_16x16x32_bf16 v[52:55], v[78:81], a[32:35], 0
    ds_read_b128 a[28:31], v86 offset:30464
    v_cvt_pk_bf16_f32 v66, v8, v9
    v_cvt_pk_bf16_f32 v67, v10, v11
    v_mfma_f32_16x16x32_bf16 v[56:59], v[74:77], a[60:63], 0
    s_waitcnt vmcnt(12)
    buffer_load_dwordx4 a[136:139], v7, s[4:7], s49 offen offset:256
    ds_write_b64 v84, v[66:67] offset:3264
    v_mfma_f32_16x16x16_bf16 v[60:63], v[72:73], a[76:77], 0
    v_cvt_pk_bf16_f32 v68, v12, v13
    v_cvt_pk_bf16_f32 v69, v14, v15
    v_mfma_f32_16x16x16_bf16 v[8:11], v[72:73], a[78:79], 0
    s_waitcnt vmcnt(12)
    ds_write_b64 v84, v[68:69] offset:3808
    v_cvt_pk_bf16_f32 v70, v52, v53
    v_cvt_pk_bf16_f32 v71, v54, v55
    v_mfma_f32_16x16x16_bf16 v[12:15], v[72:73], a[80:81], 0
    buffer_load_dwordx4 a[140:143], v7, s[4:7], s50 offen offset:256
    s_mov_b32 exec_hi, 0
    ds_write_b64 v84, v[70:71] offset:0
    s_mov_b32 exec_hi, -1
    v_cvt_pk_bf16_f32 v16, v56, v57
    v_cvt_pk_bf16_f32 v17, v58, v59
    v_mfma_f32_16x16x16_bf16 v[52:55], v[72:73], a[82:83], 0
    s_waitcnt vmcnt(12)
    s_mov_b32 exec_lo, 0
    ds_write_b64 v84, v[16:17] offset:4352
    s_mov_b32 exec_lo, -1
    v_cvt_pk_bf16_f32 v20, v60, v61
    v_cvt_pk_bf16_f32 v21, v62, v63
    v_mfma_f32_16x16x16_bf16 v[56:59], v[72:73], a[84:85], 0
    v_cvt_pk_bf16_f32 v22, v8, v9
    v_cvt_pk_bf16_f32 v23, v10, v11
    v_mfma_f32_16x16x16_bf16 v[60:63], v[72:73], a[86:87], 0
    s_waitcnt vmcnt(11)
    buffer_load_dwordx4 a[144:147], v7, s[4:7], s51 offen offset:256
    v_cvt_pk_bf16_f32 v64, v12, v13
    v_cvt_pk_bf16_f32 v65, v14, v15
    v_mfma_f32_16x16x16_bf16 v[8:11], v[72:73], a[88:89], 0
    s_waitcnt lgkmcnt(0)
    s_barrier
    ds_write_b128 v82, v[20:23] offset:0
    v_cvt_pk_bf16_f32 v66, v52, v53
    v_cvt_pk_bf16_f32 v67, v54, v55
    v_mfma_f32_16x16x16_bf16 v[12:15], v[72:73], a[90:91], 0
    s_waitcnt vmcnt(11)
    buffer_load_dwordx4 a[164:167], v7, s[4:7], 0 offen offset:384
    ds_write_b128 v82, v[64:67] offset:544
    v_cvt_pk_bf16_f32 v68, v56, v57
    v_cvt_pk_bf16_f32 v69, v58, v59
    v_mfma_f32_16x16x16_bf16 v[52:55], v[72:73], a[92:93], 0
    ds_read_b128 a[64:67], v85 offset:39168
    v_cvt_pk_bf16_f32 v70, v60, v61
    v_cvt_pk_bf16_f32 v71, v62, v63
    v_mfma_f32_16x16x16_bf16 v[56:59], v[72:73], a[94:95], 0
    s_waitcnt vmcnt(11)
    ds_write_b128 v82, v[68:71] offset:1088
    v_cvt_pk_bf16_f32 v16, v8, v9
    v_cvt_pk_bf16_f32 v17, v10, v11
    v_mfma_f32_16x16x16_bf16 v[60:63], v[72:73], a[96:97], 0
    ds_read_b128 a[68:71], v85 offset:43520
    buffer_load_dwordx4 a[168:171], v7, s[4:7], s45 offen offset:384
    v_cvt_pk_bf16_f32 v18, v12, v13
    v_cvt_pk_bf16_f32 v19, v14, v15
    v_mfma_f32_16x16x16_bf16 v[8:11], v[72:73], a[98:99], 0
    s_waitcnt vmcnt(11)
    ds_write_b128 v82, v[16:19] offset:1632
    v_cvt_pk_bf16_f32 v20, v52, v53
    v_cvt_pk_bf16_f32 v21, v54, v55
    v_mfma_f32_16x16x16_bf16 v[12:15], v[72:73], a[100:101], 0
    ds_read_b128 a[72:75], v85 offset:47872
    v_cvt_pk_bf16_f32 v22, v56, v57
    v_cvt_pk_bf16_f32 v23, v58, v59
    v_mfma_f32_16x16x16_bf16 v[52:55], v[72:73], a[102:103], 0
    s_waitcnt vmcnt(10)
    buffer_load_dwordx4 a[172:175], v7, s[4:7], s46 offen offset:384
    ds_write_b128 v82, v[20:23] offset:2176
    v_cvt_pk_bf16_f32 v64, v60, v61
    v_cvt_pk_bf16_f32 v65, v62, v63
    v_mfma_f32_16x16x16_bf16 v[56:59], v[72:73], a[104:105], 0
    v_cvt_pk_bf16_f32 v66, v8, v9
    v_cvt_pk_bf16_f32 v67, v10, v11
    v_mfma_f32_16x16x16_bf16 v[60:63], v[72:73], a[106:107], 0
    buffer_load_dwordx4 a[176:179], v7, s[4:7], s47 offen offset:384
    ds_write_b128 v82, v[64:67] offset:2720
    v_cvt_pk_bf16_f32 v68, v12, v13
    v_cvt_pk_bf16_f32 v69, v14, v15
    v_mfma_f32_16x16x32_bf16 v[8:11], v[74:77], a[76:79], 0
    v_cvt_pk_bf16_f32 v70, v52, v53
    v_cvt_pk_bf16_f32 v71, v54, v55
    v_mfma_f32_16x16x32_bf16 v[8:11], v[78:81], a[80:83], v[8:11]
    ds_write_b128 v82, v[68:71] offset:3264
    v_cvt_pk_bf16_f32 v16, v56, v57
    v_cvt_pk_bf16_f32 v17, v58, v59
    v_mfma_f32_16x16x32_bf16 v[12:15], v[74:77], a[80:83], 0
    v_cvt_pk_bf16_f32 v18, v60, v61
    v_cvt_pk_bf16_f32 v19, v62, v63
    v_mfma_f32_16x16x32_bf16 v[12:15], v[78:81], a[84:87], v[12:15]
    buffer_load_dwordx4 a[180:183], v7, s[4:7], s48 offen offset:384
    ds_write_b128 v82, v[16:19] offset:3808
    v_mfma_f32_16x16x32_bf16 v[52:55], v[74:77], a[84:87], 0
    v_cvt_pk_bf16_f32 v20, v8, v9
    v_cvt_pk_bf16_f32 v21, v10, v11
    v_mfma_f32_16x16x32_bf16 v[52:55], v[78:81], a[88:91], v[52:55]
    s_cmp_eq_u32 s20, 3
    s_cselect_b64 s[100:101], -1, 0
    v_add_u32 v84, 69888, v83
    v_cndmask_b32 v84, v83, v84, s[100:101]
    v_mfma_f32_16x16x32_bf16 v[56:59], v[74:77], a[88:91], 0
    s_waitcnt lgkmcnt(0)
    s_barrier
    buffer_store_dwordx2 v[46:47], v49, s[16:19], 0 offen sc0 sc1
    ds_write_b64 v84, v[20:21] offset:544
    v_cvt_pk_bf16_f32 v22, v12, v13
    v_cvt_pk_bf16_f32 v23, v14, v15
    v_mfma_f32_16x16x32_bf16 v[56:59], v[78:81], a[92:95], v[56:59]
    ds_read_b128 a[32:35], v85 offset:0
    buffer_load_dwordx4 a[184:187], v7, s[4:7], s49 offen offset:384
    ds_write_b64 v84, v[22:23] offset:1088
    v_mfma_f32_16x16x32_bf16 v[60:63], v[74:77], a[92:95], 0
    ds_read_b128 a[36:39], v86 offset:17408
    v_cvt_pk_bf16_f32 v64, v52, v53
    v_cvt_pk_bf16_f32 v65, v54, v55
    v_mfma_f32_16x16x32_bf16 v[60:63], v[78:81], a[96:99], v[60:63]
    ds_read_b128 a[40:43], v85 offset:4352
    ds_write_b64 v84, v[64:65] offset:1632
    v_mfma_f32_16x16x32_bf16 v[8:11], v[74:77], a[96:99], 0
    ds_read_b128 a[44:47], v86 offset:21760
    v_cvt_pk_bf16_f32 v66, v56, v57
    v_cvt_pk_bf16_f32 v67, v58, v59
    v_mfma_f32_16x16x32_bf16 v[8:11], v[78:81], a[100:103], v[8:11]
    ds_read_b128 a[48:51], v85 offset:8704
    buffer_load_dwordx4 a[188:191], v7, s[4:7], s50 offen offset:384
    ds_write_b64 v84, v[66:67] offset:2176
    v_mfma_f32_16x16x32_bf16 v[12:15], v[74:77], a[100:103], 0
    ds_read_b128 a[52:55], v86 offset:26112
    v_cvt_pk_bf16_f32 v68, v60, v61
    v_cvt_pk_bf16_f32 v69, v62, v63
    v_mfma_f32_16x16x32_bf16 v[12:15], v[78:81], a[104:107], v[12:15]
    ds_read_b128 a[56:59], v85 offset:13056
    ds_write_b64 v84, v[68:69] offset:2720
    v_mfma_f32_16x16x32_bf16 v[52:55], v[78:81], a[76:79], 0
    ds_read_b128 a[60:63], v86 offset:30464
    v_cvt_pk_bf16_f32 v70, v8, v9
    v_cvt_pk_bf16_f32 v71, v10, v11
    v_mfma_f32_16x16x32_bf16 v[56:59], v[74:77], a[104:107], 0
    s_waitcnt vmcnt(15)
    buffer_load_dwordx4 a[192:195], v7, s[4:7], s51 offen offset:384
    ds_write_b64 v84, v[70:71] offset:3264
    v_mfma_f32_16x16x16_bf16 v[60:63], v[72:73], a[116:117], 0
    v_cvt_pk_bf16_f32 v16, v12, v13
    v_cvt_pk_bf16_f32 v17, v14, v15
    v_mfma_f32_16x16x16_bf16 v[8:11], v[72:73], a[118:119], 0
    s_waitcnt vmcnt(15)
    ds_write_b64 v84, v[16:17] offset:3808
    v_cvt_pk_bf16_f32 v18, v52, v53
    v_cvt_pk_bf16_f32 v19, v54, v55
    v_mfma_f32_16x16x16_bf16 v[12:15], v[72:73], a[120:121], 0
    s_mov_b32 exec_hi, 0
    ds_write_b64 v84, v[18:19] offset:0
    s_mov_b32 exec_hi, -1
    v_cvt_pk_bf16_f32 v20, v56, v57
    v_cvt_pk_bf16_f32 v21, v58, v59
    v_mfma_f32_16x16x16_bf16 v[52:55], v[72:73], a[122:123], 0
    s_waitcnt vmcnt(14)
    buffer_load_dwordx4 a[204:207], v7, s[4:7], 0 offen offset:512
    s_mov_b32 exec_lo, 0
    ds_write_b64 v84, v[20:21] offset:4352
    s_mov_b32 exec_lo, -1
    v_cvt_pk_bf16_f32 v64, v60, v61
    v_cvt_pk_bf16_f32 v65, v62, v63
    v_mfma_f32_16x16x16_bf16 v[56:59], v[72:73], a[124:125], 0
    v_cvt_pk_bf16_f32 v66, v8, v9
    v_cvt_pk_bf16_f32 v67, v10, v11
    v_mfma_f32_16x16x16_bf16 v[60:63], v[72:73], a[126:127], 0
    s_waitcnt vmcnt(14)
    v_cvt_pk_bf16_f32 v68, v12, v13
    v_cvt_pk_bf16_f32 v69, v14, v15
    s_cmp_eq_u32 s20, 2
    s_cselect_b64 s[100:101], s[96:97], 0
    v_add_u32 v84, 82944, v82
    v_cndmask_b32 v84, v82, v84, s[100:101]
    v_mfma_f32_16x16x16_bf16 v[8:11], v[72:73], a[128:129], 0
    s_waitcnt lgkmcnt(0)
    s_barrier
    buffer_load_dwordx4 a[208:211], v7, s[4:7], s45 offen offset:512
    ds_write_b128 v84, v[64:67] offset:0
    v_cvt_pk_bf16_f32 v70, v52, v53
    v_cvt_pk_bf16_f32 v71, v54, v55
    v_mfma_f32_16x16x16_bf16 v[12:15], v[72:73], a[130:131], 0
    s_waitcnt vmcnt(14)
    ds_write_b128 v84, v[68:71] offset:544
    v_cvt_pk_bf16_f32 v16, v56, v57
    v_cvt_pk_bf16_f32 v17, v58, v59
    v_mfma_f32_16x16x16_bf16 v[52:55], v[72:73], a[132:133], 0
    ds_read_b128 a[104:107], v85 offset:34816
    v_cvt_pk_bf16_f32 v18, v60, v61
    v_cvt_pk_bf16_f32 v19, v62, v63
    v_mfma_f32_16x16x16_bf16 v[56:59], v[72:73], a[134:135], 0
    s_waitcnt vmcnt(13)
    buffer_load_dwordx4 a[212:215], v7, s[4:7], s46 offen offset:512
    ds_write_b128 v84, v[16:19] offset:1088
    v_cvt_pk_bf16_f32 v20, v8, v9
    v_cvt_pk_bf16_f32 v21, v10, v11
    v_mfma_f32_16x16x16_bf16 v[60:63], v[72:73], a[136:137], 0
    ds_read_b128 a[108:111], v85 offset:39168
    v_cvt_pk_bf16_f32 v22, v12, v13
    v_cvt_pk_bf16_f32 v23, v14, v15
    v_mfma_f32_16x16x16_bf16 v[8:11], v[72:73], a[138:139], 0
    s_waitcnt vmcnt(13)
    ds_write_b128 v84, v[20:23] offset:1632
    v_cvt_pk_bf16_f32 v64, v52, v53
    v_cvt_pk_bf16_f32 v65, v54, v55
    v_mfma_f32_16x16x16_bf16 v[12:15], v[72:73], a[140:141], 0
    ds_read_b128 a[112:115], v85 offset:43520
    buffer_load_dwordx4 a[216:219], v7, s[4:7], s47 offen offset:512
    v_cvt_pk_bf16_f32 v66, v56, v57
    v_cvt_pk_bf16_f32 v67, v58, v59
    v_mfma_f32_16x16x16_bf16 v[52:55], v[72:73], a[142:143], 0
    s_waitcnt vmcnt(13)
    ds_write_b128 v84, v[64:67] offset:2176
    v_cvt_pk_bf16_f32 v68, v60, v61
    v_cvt_pk_bf16_f32 v69, v62, v63
    v_mfma_f32_16x16x16_bf16 v[56:59], v[72:73], a[144:145], 0
    v_cvt_pk_bf16_f32 v70, v8, v9
    v_cvt_pk_bf16_f32 v71, v10, v11
    v_mfma_f32_16x16x16_bf16 v[60:63], v[72:73], a[146:147], 0
    buffer_load_dwordx4 a[220:223], v7, s[4:7], s48 offen offset:512
    ds_write_b128 v84, v[68:71] offset:2720
    v_cvt_pk_bf16_f32 v16, v12, v13
    v_cvt_pk_bf16_f32 v17, v14, v15
    v_mfma_f32_16x16x32_bf16 v[8:11], v[74:77], a[116:119], 0
    v_cvt_pk_bf16_f32 v18, v52, v53
    v_cvt_pk_bf16_f32 v19, v54, v55
    v_mfma_f32_16x16x32_bf16 v[8:11], v[78:81], a[120:123], v[8:11]
    ds_write_b128 v84, v[16:19] offset:3264
    v_cvt_pk_bf16_f32 v20, v56, v57
    v_cvt_pk_bf16_f32 v21, v58, v59
    v_mfma_f32_16x16x32_bf16 v[12:15], v[74:77], a[120:123], 0
    v_cvt_pk_bf16_f32 v22, v60, v61
    v_cvt_pk_bf16_f32 v23, v62, v63
    v_mfma_f32_16x16x32_bf16 v[12:15], v[78:81], a[124:127], v[12:15]
    ds_write_b128 v84, v[20:23] offset:3808
    v_mfma_f32_16x16x32_bf16 v[52:55], v[74:77], a[124:127], 0
    v_cvt_pk_bf16_f32 v64, v8, v9
    v_cvt_pk_bf16_f32 v65, v10, v11
    v_mfma_f32_16x16x32_bf16 v[52:55], v[78:81], a[128:131], v[52:55]
    buffer_load_dwordx4 a[224:227], v7, s[4:7], s49 offen offset:512
    v_mfma_f32_16x16x32_bf16 v[56:59], v[74:77], a[128:131], 0
    s_waitcnt lgkmcnt(0)
    s_barrier
    ds_write_b64 v83, v[64:65] offset:544
    v_cvt_pk_bf16_f32 v66, v12, v13
    v_cvt_pk_bf16_f32 v67, v14, v15
    v_mfma_f32_16x16x32_bf16 v[56:59], v[78:81], a[132:135], v[56:59]
    ds_read_b128 a[76:79], v85 offset:0
    ds_write_b64 v83, v[66:67] offset:1088
    v_mfma_f32_16x16x32_bf16 v[60:63], v[74:77], a[132:135], 0
    ds_read_b128 a[80:83], v86 offset:17408
    v_cvt_pk_bf16_f32 v68, v52, v53
    v_cvt_pk_bf16_f32 v69, v54, v55
    v_mfma_f32_16x16x32_bf16 v[60:63], v[78:81], a[136:139], v[60:63]
    ds_read_b128 a[84:87], v85 offset:4352
    ds_write_b64 v83, v[68:69] offset:1632
    v_mfma_f32_16x16x32_bf16 v[8:11], v[74:77], a[136:139], 0
    ds_read_b128 a[88:91], v86 offset:21760
    buffer_load_dwordx4 a[228:231], v7, s[4:7], s50 offen offset:512
    v_cvt_pk_bf16_f32 v70, v56, v57
    v_cvt_pk_bf16_f32 v71, v58, v59
    v_mfma_f32_16x16x32_bf16 v[8:11], v[78:81], a[140:143], v[8:11]
    ds_read_b128 a[92:95], v86 offset:26112
    ds_write_b64 v83, v[70:71] offset:2176
    v_mfma_f32_16x16x32_bf16 v[12:15], v[74:77], a[140:143], 0
    ds_read_b128 a[96:99], v85 offset:13056
    v_cvt_pk_bf16_f32 v16, v60, v61
    v_cvt_pk_bf16_f32 v17, v62, v63
    v_mfma_f32_16x16x32_bf16 v[12:15], v[78:81], a[144:147], v[12:15]
    ds_read_b128 a[100:103], v86 offset:30464
    ds_write_b64 v83, v[16:17] offset:2720
    v_mfma_f32_16x16x32_bf16 v[52:55], v[78:81], a[116:119], 0
    v_cvt_pk_bf16_f32 v18, v8, v9
    v_cvt_pk_bf16_f32 v19, v10, v11
    v_mfma_f32_16x16x32_bf16 v[56:59], v[74:77], a[144:147], 0
    s_waitcnt vmcnt(15)
    buffer_load_dwordx4 a[232:235], v7, s[4:7], s51 offen offset:512
    ds_write_b64 v83, v[18:19] offset:3264
    v_mfma_f32_16x16x16_bf16 v[60:63], v[72:73], a[164:165], 0
    v_cvt_pk_bf16_f32 v20, v12, v13
    v_cvt_pk_bf16_f32 v21, v14, v15
    v_mfma_f32_16x16x16_bf16 v[8:11], v[72:73], a[166:167], 0
    s_waitcnt vmcnt(15)
    ds_write_b64 v83, v[20:21] offset:3808
    v_cvt_pk_bf16_f32 v22, v52, v53
    v_cvt_pk_bf16_f32 v23, v54, v55
    v_mfma_f32_16x16x16_bf16 v[12:15], v[72:73], a[168:169], 0
    s_mov_b32 exec_hi, 0
    ds_write_b64 v83, v[22:23] offset:0
    s_mov_b32 exec_hi, -1
    v_cvt_pk_bf16_f32 v64, v56, v57
    v_cvt_pk_bf16_f32 v65, v58, v59
    v_mfma_f32_16x16x16_bf16 v[52:55], v[72:73], a[170:171], 0
    s_waitcnt vmcnt(14)
    buffer_load_dwordx4 a[240:243], v7, s[4:7], 0 offen offset:640
    s_mov_b32 exec_lo, 0
    ds_write_b64 v83, v[64:65] offset:4352
    s_mov_b32 exec_lo, -1
    v_cvt_pk_bf16_f32 v68, v60, v61
    v_cvt_pk_bf16_f32 v69, v62, v63
    v_mfma_f32_16x16x16_bf16 v[56:59], v[72:73], a[172:173], 0
    v_cvt_pk_bf16_f32 v70, v8, v9
    v_cvt_pk_bf16_f32 v71, v10, v11
    v_mfma_f32_16x16x16_bf16 v[60:63], v[72:73], a[174:175], 0
    s_waitcnt vmcnt(14)
    v_cvt_pk_bf16_f32 v16, v12, v13
    v_cvt_pk_bf16_f32 v17, v14, v15
    v_mfma_f32_16x16x16_bf16 v[8:11], v[72:73], a[176:177], 0
    s_waitcnt lgkmcnt(0)
    s_barrier
    buffer_load_dwordx4 a[244:247], v7, s[4:7], s45 offen offset:640
    ds_write_b128 v82, v[68:71] offset:0
    v_cvt_pk_bf16_f32 v18, v52, v53
    v_cvt_pk_bf16_f32 v19, v54, v55
    v_mfma_f32_16x16x16_bf16 v[12:15], v[72:73], a[178:179], 0
    s_waitcnt vmcnt(14)
    ds_write_b128 v82, v[16:19] offset:544
    v_cvt_pk_bf16_f32 v20, v56, v57
    v_cvt_pk_bf16_f32 v21, v58, v59
    v_mfma_f32_16x16x16_bf16 v[52:55], v[72:73], a[180:181], 0
    ds_read_b128 a[148:151], v85 offset:34816
    v_cvt_pk_bf16_f32 v22, v60, v61
    v_cvt_pk_bf16_f32 v23, v62, v63
    v_mfma_f32_16x16x16_bf16 v[56:59], v[72:73], a[182:183], 0
    s_waitcnt vmcnt(12)
    buffer_load_dwordx4 a[248:251], v7, s[4:7], s46 offen offset:640
    ds_write_b128 v82, v[20:23] offset:1088
    v_cvt_pk_bf16_f32 v64, v8, v9
    v_cvt_pk_bf16_f32 v65, v10, v11
    v_mfma_f32_16x16x16_bf16 v[60:63], v[72:73], a[184:185], 0
    ds_read_b128 a[152:155], v85 offset:39168
    v_cvt_pk_bf16_f32 v66, v12, v13
    v_cvt_pk_bf16_f32 v67, v14, v15
    v_mfma_f32_16x16x16_bf16 v[8:11], v[72:73], a[186:187], 0
    s_waitcnt vmcnt(12)
    ds_write_b128 v82, v[64:67] offset:1632
    v_cvt_pk_bf16_f32 v68, v52, v53
    v_cvt_pk_bf16_f32 v69, v54, v55
    v_mfma_f32_16x16x16_bf16 v[12:15], v[72:73], a[188:189], 0
    ds_read_b128 a[156:159], v85 offset:43520
    buffer_load_dwordx4 a[252:255], v7, s[4:7], s47 offen offset:640
    v_cvt_pk_bf16_f32 v70, v56, v57
    v_cvt_pk_bf16_f32 v71, v58, v59
    v_mfma_f32_16x16x16_bf16 v[52:55], v[72:73], a[190:191], 0
    s_waitcnt vmcnt(12)
    ds_write_b128 v82, v[68:71] offset:2176
    v_cvt_pk_bf16_f32 v16, v60, v61
    v_cvt_pk_bf16_f32 v17, v62, v63
    v_mfma_f32_16x16x16_bf16 v[56:59], v[72:73], a[192:193], 0
    ds_read_b128 a[160:163], v85 offset:47872
    v_cvt_pk_bf16_f32 v18, v8, v9
    v_cvt_pk_bf16_f32 v19, v10, v11
    v_mfma_f32_16x16x16_bf16 v[60:63], v[72:73], a[194:195], 0
    buffer_load_dwordx4 v[144:147], v7, s[4:7], s48 offen offset:640
    ds_write_b128 v82, v[16:19] offset:2720
    v_cvt_pk_bf16_f32 v20, v12, v13
    v_cvt_pk_bf16_f32 v21, v14, v15
    v_mfma_f32_16x16x32_bf16 v[8:11], v[74:77], a[164:167], 0
    v_cvt_pk_bf16_f32 v22, v52, v53
    v_cvt_pk_bf16_f32 v23, v54, v55
    v_lshlrev_b32 v96, 16, v88
    v_and_b32 v97, s29, v88
    v_lshlrev_b32 v98, 16, v89
    v_mfma_f32_16x16x32_bf16 v[8:11], v[78:81], a[168:171], v[8:11]
    ds_write_b128 v82, v[20:23] offset:3264
    v_cvt_pk_bf16_f32 v64, v56, v57
    v_cvt_pk_bf16_f32 v65, v58, v59
    v_and_b32 v99, s29, v89
    v_lshlrev_b32 v100, 16, v90
    v_and_b32 v101, s29, v90
    v_mfma_f32_16x16x32_bf16 v[12:15], v[74:77], a[168:171], 0
    v_cvt_pk_bf16_f32 v66, v60, v61
    v_cvt_pk_bf16_f32 v67, v62, v63
    v_lshlrev_b32 v102, 16, v91
    v_and_b32 v103, s29, v91
    v_add_f32 v98, 925353388, v98
    v_mfma_f32_16x16x32_bf16 v[12:15], v[78:81], a[172:175], v[12:15]
    ds_write_b128 v82, v[64:67] offset:3808
    v_cvt_pk_bf16_f32 v98, v98, v98
    v_and_b32 v98, s29, v98
    v_add_f32 v99, 925353388, v99
    v_mfma_f32_16x16x32_bf16 v[52:55], v[74:77], a[172:175], 0
    v_cvt_pk_bf16_f32 v68, v8, v9
    v_cvt_pk_bf16_f32 v69, v10, v11
    v_cvt_pk_bf16_f32 v99, v99, v99
    v_and_b32 v99, s29, v99
    v_sqrt_f32 v98, v98
    v_mfma_f32_16x16x32_bf16 v[52:55], v[78:81], a[176:179], v[52:55]
    buffer_load_dwordx4 v[148:151], v7, s[4:7], s49 offen offset:640
    s_cmp_eq_u32 s20, 2
    s_cselect_b64 s[100:101], -1, 0
    v_add_u32 v84, 78592, v83
    v_cndmask_b32 v84, v83, v84, s[100:101]
    v_sqrt_f32 v99, v99
    v_cvt_pk_bf16_f32 v98, v98, v98
    v_mfma_f32_16x16x32_bf16 v[56:59], v[74:77], a[176:179], 0
    s_waitcnt lgkmcnt(0)
    s_barrier
    ds_write_b64 v84, v[68:69] offset:544
    v_cvt_pk_bf16_f32 v70, v12, v13
    v_cvt_pk_bf16_f32 v71, v14, v15
    v_and_b32 v98, s29, v98
    v_cvt_pk_bf16_f32 v99, v99, v99
    v_and_b32 v99, s29, v99
    v_mfma_f32_16x16x32_bf16 v[56:59], v[78:81], a[180:183], v[56:59]
    ds_read_b128 a[116:119], v85 offset:0
    ds_write_b64 v84, v[70:71] offset:1088
    v_rcp_f32 v98, v98
    v_rcp_f32 v99, v99
    v_cvt_pk_bf16_f32 v98, v98, v98
    v_mfma_f32_16x16x32_bf16 v[60:63], v[74:77], a[180:183], 0
    ds_read_b128 a[120:123], v86 offset:17408
    v_cvt_pk_bf16_f32 v16, v52, v53
    v_cvt_pk_bf16_f32 v17, v54, v55
    v_and_b32 v98, s29, v98
    v_cvt_pk_bf16_f32 v99, v99, v99
    v_and_b32 v99, s29, v99
    v_mfma_f32_16x16x32_bf16 v[60:63], v[78:81], a[184:187], v[60:63]
    ds_read_b128 a[124:127], v85 offset:4352
    ds_write_b64 v84, v[16:17] offset:1632
    v_mul_f32 v98, v100, v98
    v_cvt_pk_bf16_f32 v98, v98, v98
    v_and_b32 v98, s29, v98
    v_mfma_f32_16x16x32_bf16 v[8:11], v[74:77], a[184:187], 0
    ds_read_b128 a[128:131], v86 offset:21760
    buffer_load_dwordx4 v[152:155], v7, s[4:7], s50 offen offset:640
    v_cvt_pk_bf16_f32 v18, v56, v57
    v_cvt_pk_bf16_f32 v19, v58, v59
    v_mul_f32 v99, v101, v99
    v_cvt_pk_bf16_f32 v99, v99, v99
    v_mfma_f32_16x16x32_bf16 v[8:11], v[78:81], a[188:191], v[8:11]
    ds_read_b128 a[132:135], v85 offset:8704
    ds_write_b64 v84, v[18:19] offset:2176
    v_and_b32 v99, s29, v99
    v_fma_f32 v102, -v96, v98, v102
    v_fma_f32 v103, -v97, v99, v103
    v_mfma_f32_16x16x32_bf16 v[12:15], v[74:77], a[188:191], 0
    ds_read_b128 a[136:139], v86 offset:26112
    v_cvt_pk_bf16_f32 v20, v60, v61
    v_cvt_pk_bf16_f32 v21, v62, v63
    v_mul_f32 v104, 3209280542, v102
    v_mul_f32 v105, 3209280542, v103
    ds_write_b64 v92, v[104:105] offset:0
    v_mfma_f32_16x16x32_bf16 v[12:15], v[78:81], a[192:195], v[12:15]
    ds_read_b128 a[140:143], v85 offset:13056
    ds_write_b64 v84, v[20:21] offset:2720
    v_mul_f32 v106, 1044002686, v102
    v_mul_f32 v107, 1044002686, v103
    ds_write_b64 v92, v[106:107] offset:1152
    v_mfma_f32_16x16x32_bf16 v[52:55], v[78:81], a[164:167], 0
    ds_read_b128 a[144:147], v86 offset:30464
    v_cvt_pk_bf16_f32 v22, v8, v9
    v_cvt_pk_bf16_f32 v23, v10, v11
    v_mul_f32 v108, 3210933154, v102
    v_mul_f32 v109, 3210933154, v103
    ds_write_b64 v92, v[108:109] offset:2304
    v_mfma_f32_16x16x32_bf16 v[56:59], v[74:77], a[192:195], 0
    buffer_load_dwordx4 v[156:159], v7, s[4:7], s51 offen offset:640
    ds_write_b64 v84, v[22:23] offset:3264
    v_mul_f32 v110, 3191181237, v102
    v_mul_f32 v111, 3191181237, v103
    s_waitcnt vmcnt(15)
    ds_write_b64 v92, v[110:111] offset:3456
    v_mfma_f32_16x16x16_bf16 v[60:63], v[72:73], a[204:205], 0
    v_cvt_pk_bf16_f32 v64, v12, v13
    v_cvt_pk_bf16_f32 v65, v14, v15
    v_mfma_f32_16x16x16_bf16 v[8:11], v[72:73], a[206:207], 0
    s_waitcnt vmcnt(14)
    ds_write_b64 v84, v[64:65] offset:3808
    v_cvt_pk_bf16_f32 v66, v52, v53
    v_cvt_pk_bf16_f32 v67, v54, v55
    v_mfma_f32_16x16x16_bf16 v[12:15], v[72:73], a[208:209], 0
    s_mov_b32 exec_hi, 0
    ds_write_b64 v84, v[66:67] offset:0
    s_mov_b32 exec_hi, -1
    v_cvt_pk_bf16_f32 v68, v56, v57
    v_cvt_pk_bf16_f32 v69, v58, v59
    v_mfma_f32_16x16x16_bf16 v[52:55], v[72:73], a[210:211], 0
    s_waitcnt vmcnt(13)
    buffer_load_dwordx4 v[172:175], v7, s[4:7], 0 offen offset:768
    s_mov_b32 exec_lo, 0
    ds_write_b64 v84, v[68:69] offset:4352
    s_mov_b32 exec_lo, -1
    v_cvt_pk_bf16_f32 v16, v60, v61
    v_cvt_pk_bf16_f32 v17, v62, v63
    v_mfma_f32_16x16x16_bf16 v[56:59], v[72:73], a[212:213], 0
    v_cvt_pk_bf16_f32 v18, v8, v9
    v_cvt_pk_bf16_f32 v19, v10, v11
    v_mfma_f32_16x16x16_bf16 v[60:63], v[72:73], a[214:215], 0
    s_waitcnt vmcnt(13)
    v_cvt_pk_bf16_f32 v20, v12, v13
    v_cvt_pk_bf16_f32 v21, v14, v15
    s_cmp_eq_u32 s20, 1
    s_cselect_b64 s[100:101], s[96:97], 0
    v_add_u32 v84, 91648, v82
    v_cndmask_b32 v84, v82, v84, s[100:101]
    v_mfma_f32_16x16x16_bf16 v[8:11], v[72:73], a[216:217], 0
    s_waitcnt lgkmcnt(0)
    s_barrier
    buffer_load_dwordx4 v[176:179], v7, s[4:7], s45 offen offset:768
    ds_write_b128 v84, v[16:19] offset:0
    v_cvt_pk_bf16_f32 v22, v52, v53
    v_cvt_pk_bf16_f32 v23, v54, v55
    v_mfma_f32_16x16x16_bf16 v[12:15], v[72:73], a[218:219], 0
    s_waitcnt vmcnt(13)
    ds_write_b128 v84, v[20:23] offset:544
    v_cvt_pk_bf16_f32 v64, v56, v57
    v_cvt_pk_bf16_f32 v65, v58, v59
    v_mfma_f32_16x16x16_bf16 v[52:55], v[72:73], a[220:221], 0
    ds_read_b128 a[192:195], v85 offset:34816
    v_cvt_pk_bf16_f32 v66, v60, v61
    v_cvt_pk_bf16_f32 v67, v62, v63
    v_mfma_f32_16x16x16_bf16 v[56:59], v[72:73], a[222:223], 0
    s_waitcnt vmcnt(12)
    buffer_load_dwordx4 v[180:183], v7, s[4:7], s46 offen offset:768
    ds_write_b128 v84, v[64:67] offset:1088
    v_cvt_pk_bf16_f32 v68, v8, v9
    v_cvt_pk_bf16_f32 v69, v10, v11
    v_mfma_f32_16x16x16_bf16 v[60:63], v[72:73], a[224:225], 0
    ds_read_b128 a[196:199], v85 offset:39168
    v_cvt_pk_bf16_f32 v70, v12, v13
    v_cvt_pk_bf16_f32 v71, v14, v15
    v_mfma_f32_16x16x16_bf16 v[8:11], v[72:73], a[226:227], 0
    s_waitcnt vmcnt(12)
    ds_write_b128 v84, v[68:71] offset:1632
    v_cvt_pk_bf16_f32 v16, v52, v53
    v_cvt_pk_bf16_f32 v17, v54, v55
    v_mfma_f32_16x16x16_bf16 v[12:15], v[72:73], a[228:229], 0
    ds_read_b128 a[200:203], v85 offset:47872
    buffer_load_dwordx4 v[184:187], v7, s[4:7], s47 offen offset:768
    v_cvt_pk_bf16_f32 v18, v56, v57
    v_cvt_pk_bf16_f32 v19, v58, v59
    v_mfma_f32_16x16x16_bf16 v[52:55], v[72:73], a[230:231], 0
    s_waitcnt vmcnt(12)
    ds_write_b128 v84, v[16:19] offset:2176
    v_cvt_pk_bf16_f32 v20, v60, v61
    v_cvt_pk_bf16_f32 v21, v62, v63
    v_mfma_f32_16x16x16_bf16 v[56:59], v[72:73], a[232:233], 0
    v_cvt_pk_bf16_f32 v22, v8, v9
    v_cvt_pk_bf16_f32 v23, v10, v11
    v_mfma_f32_16x16x16_bf16 v[60:63], v[72:73], a[234:235], 0
    buffer_load_dwordx4 v[188:191], v7, s[4:7], s48 offen offset:768
    ds_write_b128 v84, v[20:23] offset:2720
    v_cvt_pk_bf16_f32 v64, v12, v13
    v_cvt_pk_bf16_f32 v65, v14, v15
    v_mfma_f32_16x16x32_bf16 v[8:11], v[74:77], a[204:207], 0
    v_cvt_pk_bf16_f32 v66, v52, v53
    v_cvt_pk_bf16_f32 v67, v54, v55
    v_mfma_f32_16x16x32_bf16 v[8:11], v[78:81], a[208:211], v[8:11]
    ds_write_b128 v84, v[64:67] offset:3264
    v_cvt_pk_bf16_f32 v68, v56, v57
    v_cvt_pk_bf16_f32 v69, v58, v59
    v_mfma_f32_16x16x32_bf16 v[12:15], v[74:77], a[208:211], 0
    v_cvt_pk_bf16_f32 v70, v60, v61
    v_cvt_pk_bf16_f32 v71, v62, v63
    v_mfma_f32_16x16x32_bf16 v[12:15], v[78:81], a[212:215], v[12:15]
    ds_write_b128 v84, v[68:71] offset:3808
    v_mfma_f32_16x16x32_bf16 v[52:55], v[74:77], a[212:215], 0
    v_cvt_pk_bf16_f32 v16, v8, v9
    v_cvt_pk_bf16_f32 v17, v10, v11
    v_mfma_f32_16x16x32_bf16 v[52:55], v[78:81], a[216:219], v[52:55]
    buffer_load_dwordx4 v[192:195], v7, s[4:7], s49 offen offset:768
    s_cmp_ge_u32 s20, 2
    s_cselect_b64 s[100:101], -1, 0
    v_add_u32 v84, 39424, v83
    v_cndmask_b32 v84, v83, v84, s[100:101]
    v_mfma_f32_16x16x32_bf16 v[56:59], v[74:77], a[216:219], 0
    s_waitcnt lgkmcnt(0)
    s_barrier
    buffer_load_dwordx2 v[44:45], v48, s[16:19], 0 offen sc1
    ds_write_b64 v84, v[16:17] offset:544
    v_cvt_pk_bf16_f32 v18, v12, v13
    v_cvt_pk_bf16_f32 v19, v14, v15
    v_mfma_f32_16x16x32_bf16 v[56:59], v[78:81], a[220:223], v[56:59]
    ds_read_b128 a[164:167], v85 offset:0
    ds_write_b64 v84, v[18:19] offset:1088
    v_mfma_f32_16x16x32_bf16 v[60:63], v[74:77], a[220:223], 0
    ds_read_b128 a[168:171], v86 offset:17408
    v_cvt_pk_bf16_f32 v20, v52, v53
    v_cvt_pk_bf16_f32 v21, v54, v55
    v_mfma_f32_16x16x32_bf16 v[60:63], v[78:81], a[224:227], v[60:63]
    ds_read_b128 a[172:175], v86 offset:21760
    ds_write_b64 v84, v[20:21] offset:1632
    v_mfma_f32_16x16x32_bf16 v[8:11], v[74:77], a[224:227], 0
    ds_read_b128 a[176:179], v85 offset:8704
    buffer_load_dwordx4 v[196:199], v7, s[4:7], s50 offen offset:768
    v_cvt_pk_bf16_f32 v22, v56, v57
    v_cvt_pk_bf16_f32 v23, v58, v59
    v_mfma_f32_16x16x32_bf16 v[8:11], v[78:81], a[228:231], v[8:11]
    ds_read_b128 a[180:183], v86 offset:26112
    ds_write_b64 v84, v[22:23] offset:2176
    v_mfma_f32_16x16x32_bf16 v[12:15], v[74:77], a[228:231], 0
    ds_read_b128 a[184:187], v85 offset:13056
    v_cvt_pk_bf16_f32 v64, v60, v61
    v_cvt_pk_bf16_f32 v65, v62, v63
    v_mfma_f32_16x16x32_bf16 v[12:15], v[78:81], a[232:235], v[12:15]
    ds_read_b128 a[188:191], v86 offset:30464
    ds_write_b64 v84, v[64:65] offset:2720
    v_mfma_f32_16x16x32_bf16 v[52:55], v[78:81], a[204:207], 0
    v_cvt_pk_bf16_f32 v66, v8, v9
    v_cvt_pk_bf16_f32 v67, v10, v11
    v_mfma_f32_16x16x32_bf16 v[56:59], v[74:77], a[232:235], 0
    s_waitcnt vmcnt(15)
    buffer_load_dwordx4 v[200:203], v7, s[4:7], s51 offen offset:768
    ds_write_b64 v84, v[66:67] offset:3264
    v_mfma_f32_16x16x16_bf16 v[60:63], v[72:73], a[240:241], 0
    v_cvt_pk_bf16_f32 v68, v12, v13
    v_cvt_pk_bf16_f32 v69, v14, v15
    v_mfma_f32_16x16x16_bf16 v[8:11], v[72:73], a[242:243], 0
    s_waitcnt vmcnt(15)
    ds_write_b64 v84, v[68:69] offset:3808
    v_cvt_pk_bf16_f32 v70, v52, v53
    v_cvt_pk_bf16_f32 v71, v54, v55
    v_mfma_f32_16x16x16_bf16 v[12:15], v[72:73], a[244:245], 0
    s_mov_b32 exec_hi, 0
    ds_write_b64 v84, v[70:71] offset:0
    s_mov_b32 exec_hi, -1
    v_cvt_pk_bf16_f32 v16, v56, v57
    v_cvt_pk_bf16_f32 v17, v58, v59
    v_mfma_f32_16x16x16_bf16 v[52:55], v[72:73], a[246:247], 0
    s_waitcnt vmcnt(14)
    buffer_load_dwordx4 v[212:215], v7, s[4:7], 0 offen offset:896
    s_mov_b32 exec_lo, 0
    ds_write_b64 v84, v[16:17] offset:4352
    s_mov_b32 exec_lo, -1
    v_cvt_pk_bf16_f32 v20, v60, v61
    v_cvt_pk_bf16_f32 v21, v62, v63
    v_mfma_f32_16x16x16_bf16 v[56:59], v[72:73], a[248:249], 0
    v_cvt_pk_bf16_f32 v22, v8, v9
    v_cvt_pk_bf16_f32 v23, v10, v11
    v_mfma_f32_16x16x16_bf16 v[60:63], v[72:73], a[250:251], 0
    s_waitcnt vmcnt(14)
    v_cvt_pk_bf16_f32 v64, v12, v13
    v_cvt_pk_bf16_f32 v65, v14, v15
    s_cmp_eq_u32 s20, 1
    s_cselect_b64 s[100:101], s[96:97], 0
    v_add_u32 v84, 96000, v82
    v_cndmask_b32 v84, v82, v84, s[100:101]
    v_mfma_f32_16x16x16_bf16 v[8:11], v[72:73], a[252:253], 0
    s_waitcnt lgkmcnt(0)
    s_barrier
    buffer_load_dwordx4 v[216:219], v7, s[4:7], s45 offen offset:896
    ds_write_b128 v84, v[20:23] offset:0
    v_cvt_pk_bf16_f32 v66, v52, v53
    v_cvt_pk_bf16_f32 v67, v54, v55
    v_mfma_f32_16x16x16_bf16 v[12:15], v[72:73], a[254:255], 0
    s_waitcnt vmcnt(14)
    ds_write_b128 v84, v[64:67] offset:544
    v_cvt_pk_bf16_f32 v68, v56, v57
    v_cvt_pk_bf16_f32 v69, v58, v59
    v_mfma_f32_16x16x16_bf16 v[52:55], v[72:73], v[144:145], 0
    ds_read_b128 a[232:235], v85 offset:34816
    v_cvt_pk_bf16_f32 v70, v60, v61
    v_cvt_pk_bf16_f32 v71, v62, v63
    v_mfma_f32_16x16x16_bf16 v[56:59], v[72:73], v[146:147], 0
    s_waitcnt vmcnt(13)
    buffer_load_dwordx4 v[220:223], v7, s[4:7], s46 offen offset:896
    ds_write_b128 v84, v[68:71] offset:1088
    v_cvt_pk_bf16_f32 v16, v8, v9
    v_cvt_pk_bf16_f32 v17, v10, v11
    v_mfma_f32_16x16x16_bf16 v[60:63], v[72:73], v[148:149], 0
    v_cvt_pk_bf16_f32 v18, v12, v13
    v_cvt_pk_bf16_f32 v19, v14, v15
    v_mfma_f32_16x16x16_bf16 v[8:11], v[72:73], v[150:151], 0
    s_waitcnt vmcnt(13)
    ds_write_b128 v84, v[16:19] offset:1632
    v_cvt_pk_bf16_f32 v20, v52, v53
    v_cvt_pk_bf16_f32 v21, v54, v55
    v_mfma_f32_16x16x16_bf16 v[12:15], v[72:73], v[152:153], 0
    ds_read_b128 a[236:239], v85 offset:39168
    buffer_load_dwordx4 v[224:227], v7, s[4:7], s47 offen offset:896
    v_cvt_pk_bf16_f32 v22, v56, v57
    v_cvt_pk_bf16_f32 v23, v58, v59
    v_mfma_f32_16x16x16_bf16 v[52:55], v[72:73], v[154:155], 0
    s_waitcnt vmcnt(13)
    ds_write_b128 v84, v[20:23] offset:2176
    v_cvt_pk_bf16_f32 v64, v60, v61
    v_cvt_pk_bf16_f32 v65, v62, v63
    v_mfma_f32_16x16x16_bf16 v[56:59], v[72:73], v[156:157], 0
    v_cvt_pk_bf16_f32 v66, v8, v9
    v_cvt_pk_bf16_f32 v67, v10, v11
    v_mfma_f32_16x16x16_bf16 v[60:63], v[72:73], v[158:159], 0
    buffer_load_dwordx4 v[228:231], v7, s[4:7], s48 offen offset:896
    ds_write_b128 v84, v[64:67] offset:2720
    v_cvt_pk_bf16_f32 v68, v12, v13
    v_cvt_pk_bf16_f32 v69, v14, v15
    v_mfma_f32_16x16x32_bf16 v[8:11], v[74:77], a[240:243], 0
    v_cvt_pk_bf16_f32 v70, v52, v53
    v_cvt_pk_bf16_f32 v71, v54, v55
    v_mfma_f32_16x16x32_bf16 v[8:11], v[78:81], a[244:247], v[8:11]
    ds_write_b128 v84, v[68:71] offset:3264
    v_cvt_pk_bf16_f32 v16, v56, v57
    v_cvt_pk_bf16_f32 v17, v58, v59
    v_mfma_f32_16x16x32_bf16 v[12:15], v[74:77], a[244:247], 0
    v_cvt_pk_bf16_f32 v18, v60, v61
    v_cvt_pk_bf16_f32 v19, v62, v63
    v_mfma_f32_16x16x32_bf16 v[12:15], v[78:81], a[248:251], v[12:15]
    ds_write_b128 v84, v[16:19] offset:3808
    v_mfma_f32_16x16x32_bf16 v[52:55], v[74:77], a[248:251], 0
    v_cvt_pk_bf16_f32 v20, v8, v9
    v_cvt_pk_bf16_f32 v21, v10, v11
    v_mfma_f32_16x16x32_bf16 v[52:55], v[78:81], a[252:255], v[52:55]
    buffer_load_dwordx4 v[232:235], v7, s[4:7], s49 offen offset:896
    v_mfma_f32_16x16x32_bf16 v[56:59], v[74:77], a[252:255], 0
    s_waitcnt lgkmcnt(0)
    s_barrier
    ds_write_b64 v83, v[20:21] offset:544
    v_cvt_pk_bf16_f32 v22, v12, v13
    v_cvt_pk_bf16_f32 v23, v14, v15
    v_mfma_f32_16x16x32_bf16 v[56:59], v[78:81], v[144:147], v[56:59]
    ds_read_b128 a[204:207], v85 offset:0
    ds_write_b64 v83, v[22:23] offset:1088
    v_mfma_f32_16x16x32_bf16 v[60:63], v[74:77], v[144:147], 0
    ds_read_b128 a[208:211], v86 offset:17408
    v_cvt_pk_bf16_f32 v64, v52, v53
    v_cvt_pk_bf16_f32 v65, v54, v55
    v_mfma_f32_16x16x32_bf16 v[60:63], v[78:81], v[148:151], v[60:63]
    ds_read_b128 a[212:215], v86 offset:21760
    ds_write_b64 v83, v[64:65] offset:1632
    v_mfma_f32_16x16x32_bf16 v[8:11], v[74:77], v[148:151], 0
    ds_read_b128 a[216:219], v85 offset:8704
    buffer_load_dwordx4 v[236:239], v7, s[4:7], s50 offen offset:896
    v_cvt_pk_bf16_f32 v66, v56, v57
    v_cvt_pk_bf16_f32 v67, v58, v59
    v_mfma_f32_16x16x32_bf16 v[8:11], v[78:81], v[152:155], v[8:11]
    ds_read_b128 a[220:223], v86 offset:26112
    ds_write_b64 v83, v[66:67] offset:2176
    v_mfma_f32_16x16x32_bf16 v[12:15], v[74:77], v[152:155], 0
    ds_read_b128 a[224:227], v85 offset:13056
    v_cvt_pk_bf16_f32 v68, v60, v61
    v_cvt_pk_bf16_f32 v69, v62, v63
    v_mfma_f32_16x16x32_bf16 v[12:15], v[78:81], v[156:159], v[12:15]
    ds_read_b128 a[228:231], v86 offset:30464
    ds_write_b64 v83, v[68:69] offset:2720
    v_mfma_f32_16x16x32_bf16 v[52:55], v[78:81], a[240:243], 0
    v_cvt_pk_bf16_f32 v70, v8, v9
    v_cvt_pk_bf16_f32 v71, v10, v11
    v_mfma_f32_16x16x32_bf16 v[56:59], v[74:77], v[156:159], 0
    s_waitcnt vmcnt(15)
    buffer_load_dwordx4 v[240:243], v7, s[4:7], s51 offen offset:896
    ds_write_b64 v83, v[70:71] offset:3264
    v_mfma_f32_16x16x16_bf16 v[60:63], v[72:73], v[172:173], 0
    v_cvt_pk_bf16_f32 v16, v12, v13
    v_cvt_pk_bf16_f32 v17, v14, v15
    v_mfma_f32_16x16x16_bf16 v[8:11], v[72:73], v[174:175], 0
    s_waitcnt vmcnt(15)
    ds_write_b64 v83, v[16:17] offset:3808
    v_cvt_pk_bf16_f32 v18, v52, v53
    v_cvt_pk_bf16_f32 v19, v54, v55
    v_mfma_f32_16x16x16_bf16 v[12:15], v[72:73], v[176:177], 0
    s_mov_b32 exec_hi, 0
    ds_write_b64 v83, v[18:19] offset:0
    s_mov_b32 exec_hi, -1
    v_cvt_pk_bf16_f32 v20, v56, v57
    v_cvt_pk_bf16_f32 v21, v58, v59
    v_mfma_f32_16x16x16_bf16 v[52:55], v[72:73], v[178:179], 0
    s_waitcnt vmcnt(14)
    buffer_load_dwordx4 v[244:247], v7, s[4:7], 0 offen offset:1024
    s_mov_b32 exec_lo, 0
    ds_write_b64 v83, v[20:21] offset:4352
    s_mov_b32 exec_lo, -1
    v_cvt_pk_bf16_f32 v64, v60, v61
    v_cvt_pk_bf16_f32 v65, v62, v63
    v_mfma_f32_16x16x16_bf16 v[56:59], v[72:73], v[180:181], 0
    v_cvt_pk_bf16_f32 v66, v8, v9
    v_cvt_pk_bf16_f32 v67, v10, v11
    v_mfma_f32_16x16x16_bf16 v[60:63], v[72:73], v[182:183], 0
    s_waitcnt vmcnt(14)
    v_cvt_pk_bf16_f32 v68, v12, v13
    v_cvt_pk_bf16_f32 v69, v14, v15
    s_cmp_eq_u32 s20, 0
    s_cselect_b64 s[100:101], s[98:99], 0
    v_add_u32 v84, 87296, v82
    v_cndmask_b32 v84, v82, v84, s[100:101]
    v_mfma_f32_16x16x16_bf16 v[8:11], v[72:73], v[184:185], 0
    s_waitcnt lgkmcnt(0)
    s_barrier
    buffer_load_dwordx4 v[248:251], v7, s[4:7], s45 offen offset:1024
    ds_write_b128 v84, v[64:67] offset:0
    v_cvt_pk_bf16_f32 v70, v52, v53
    v_cvt_pk_bf16_f32 v71, v54, v55
    v_mfma_f32_16x16x16_bf16 v[12:15], v[72:73], v[186:187], 0
    s_waitcnt vmcnt(14)
    ds_write_b128 v84, v[68:71] offset:544
    v_cvt_pk_bf16_f32 v16, v56, v57
    v_cvt_pk_bf16_f32 v17, v58, v59
    v_mfma_f32_16x16x16_bf16 v[52:55], v[72:73], v[188:189], 0
    ds_read_b128 v[156:159], v85 offset:34816
    v_cvt_pk_bf16_f32 v18, v60, v61
    v_cvt_pk_bf16_f32 v19, v62, v63
    v_mfma_f32_16x16x16_bf16 v[56:59], v[72:73], v[190:191], 0
    s_waitcnt vmcnt(13)
    buffer_load_dwordx4 v[252:255], v7, s[4:7], s46 offen offset:1024
    ds_write_b128 v84, v[16:19] offset:1088
    v_cvt_pk_bf16_f32 v20, v8, v9
    v_cvt_pk_bf16_f32 v21, v10, v11
    v_mfma_f32_16x16x16_bf16 v[60:63], v[72:73], v[192:193], 0
    ds_read_b128 v[160:163], v85 offset:39168
    v_cvt_pk_bf16_f32 v22, v12, v13
    v_cvt_pk_bf16_f32 v23, v14, v15
    v_mfma_f32_16x16x16_bf16 v[8:11], v[72:73], v[194:195], 0
    s_waitcnt vmcnt(12)
    ds_write_b128 v84, v[20:23] offset:1632
    v_cvt_pk_bf16_f32 v64, v52, v53
    v_cvt_pk_bf16_f32 v65, v54, v55
    v_mfma_f32_16x16x16_bf16 v[12:15], v[72:73], v[196:197], 0
    ds_read_b128 v[164:167], v85 offset:43520
    buffer_load_dwordx4 v[24:27], v7, s[4:7], s47 offen offset:1024
    v_cvt_pk_bf16_f32 v66, v56, v57
    v_cvt_pk_bf16_f32 v67, v58, v59
    v_mfma_f32_16x16x16_bf16 v[52:55], v[72:73], v[198:199], 0
    s_waitcnt vmcnt(12)
    ds_write_b128 v84, v[64:67] offset:2176
    v_cvt_pk_bf16_f32 v68, v60, v61
    v_cvt_pk_bf16_f32 v69, v62, v63
    v_mfma_f32_16x16x16_bf16 v[56:59], v[72:73], v[200:201], 0
    ds_read_b128 v[168:171], v85 offset:47872
    v_cvt_pk_bf16_f32 v70, v8, v9
    v_cvt_pk_bf16_f32 v71, v10, v11
    v_mfma_f32_16x16x16_bf16 v[60:63], v[72:73], v[202:203], 0
    buffer_load_dwordx4 v[28:31], v7, s[4:7], s48 offen offset:1024
    ds_write_b128 v84, v[68:71] offset:2720
    v_cvt_pk_bf16_f32 v16, v12, v13
    v_cvt_pk_bf16_f32 v17, v14, v15
    v_mfma_f32_16x16x32_bf16 v[8:11], v[74:77], v[172:175], 0
    v_cvt_pk_bf16_f32 v18, v52, v53
    v_cvt_pk_bf16_f32 v19, v54, v55
    v_mfma_f32_16x16x32_bf16 v[8:11], v[78:81], v[176:179], v[8:11]
    ds_write_b128 v84, v[16:19] offset:3264
    v_cvt_pk_bf16_f32 v20, v56, v57
    v_cvt_pk_bf16_f32 v21, v58, v59
    v_mfma_f32_16x16x32_bf16 v[12:15], v[74:77], v[176:179], 0
    v_cvt_pk_bf16_f32 v22, v60, v61
    v_cvt_pk_bf16_f32 v23, v62, v63
    v_mfma_f32_16x16x32_bf16 v[12:15], v[78:81], v[180:183], v[12:15]
    ds_write_b128 v84, v[20:23] offset:3808
    v_mfma_f32_16x16x32_bf16 v[52:55], v[74:77], v[180:183], 0
    v_cvt_pk_bf16_f32 v64, v8, v9
    v_cvt_pk_bf16_f32 v65, v10, v11
    v_mfma_f32_16x16x32_bf16 v[52:55], v[78:81], v[184:187], v[52:55]
    buffer_load_dwordx4 v[32:35], v7, s[4:7], s49 offen offset:1024
    s_cmp_eq_u32 s20, 1
    s_cselect_b64 s[100:101], -1, 0
    v_add_u32 v84, 87296, v83
    v_cndmask_b32 v84, v83, v84, s[100:101]
    v_mfma_f32_16x16x32_bf16 v[56:59], v[74:77], v[184:187], 0
    s_waitcnt lgkmcnt(0)
    s_barrier
    ds_write_b64 v84, v[64:65] offset:544
    v_cvt_pk_bf16_f32 v66, v12, v13
    v_cvt_pk_bf16_f32 v67, v14, v15
    v_mfma_f32_16x16x32_bf16 v[56:59], v[78:81], v[188:191], v[56:59]
    ds_read_b128 a[240:243], v85 offset:0
    ds_write_b64 v84, v[66:67] offset:1088
    v_mfma_f32_16x16x32_bf16 v[60:63], v[74:77], v[188:191], 0
    ds_read_b128 a[244:247], v85 offset:4352
    v_cvt_pk_bf16_f32 v68, v52, v53
    v_cvt_pk_bf16_f32 v69, v54, v55
    v_mfma_f32_16x16x32_bf16 v[60:63], v[78:81], v[192:195], v[60:63]
    ds_read_b128 a[248:251], v86 offset:21760
    ds_write_b64 v84, v[68:69] offset:1632
    v_mfma_f32_16x16x32_bf16 v[8:11], v[74:77], v[192:195], 0
    ds_read_b128 a[252:255], v85 offset:8704
    buffer_load_dwordx4 v[36:39], v7, s[4:7], s50 offen offset:1024
    v_cvt_pk_bf16_f32 v70, v56, v57
    v_cvt_pk_bf16_f32 v71, v58, v59
    v_mfma_f32_16x16x32_bf16 v[8:11], v[78:81], v[196:199], v[8:11]
    ds_read_b128 v[144:147], v86 offset:26112
    ds_write_b64 v84, v[70:71] offset:2176
    v_mfma_f32_16x16x32_bf16 v[12:15], v[74:77], v[196:199], 0
    ds_read_b128 v[148:151], v85 offset:13056
    v_cvt_pk_bf16_f32 v16, v60, v61
    v_cvt_pk_bf16_f32 v17, v62, v63
    v_mfma_f32_16x16x32_bf16 v[12:15], v[78:81], v[200:203], v[12:15]
    ds_read_b128 v[152:155], v86 offset:30464
    ds_write_b64 v84, v[16:17] offset:2720
    v_mfma_f32_16x16x32_bf16 v[52:55], v[78:81], v[172:175], 0
    v_cvt_pk_bf16_f32 v18, v8, v9
    v_cvt_pk_bf16_f32 v19, v10, v11
    v_mfma_f32_16x16x32_bf16 v[56:59], v[74:77], v[200:203], 0
    s_waitcnt vmcnt(14)
    buffer_load_dwordx4 v[40:43], v7, s[4:7], s51 offen offset:1024
    ds_write_b64 v84, v[18:19] offset:3264
    v_mfma_f32_16x16x16_bf16 v[60:63], v[72:73], v[212:213], 0
    v_cvt_pk_bf16_f32 v20, v12, v13
    v_cvt_pk_bf16_f32 v21, v14, v15
    v_mfma_f32_16x16x16_bf16 v[8:11], v[72:73], v[214:215], 0
    s_waitcnt vmcnt(14)
    ds_write_b64 v84, v[20:21] offset:3808
    v_cvt_pk_bf16_f32 v22, v52, v53
    v_cvt_pk_bf16_f32 v23, v54, v55
    v_mfma_f32_16x16x16_bf16 v[12:15], v[72:73], v[216:217], 0
    s_mov_b32 exec_hi, 0
    ds_write_b64 v84, v[22:23] offset:0
    s_mov_b32 exec_hi, -1
    v_cvt_pk_bf16_f32 v64, v56, v57
    v_cvt_pk_bf16_f32 v65, v58, v59
    v_mfma_f32_16x16x16_bf16 v[52:55], v[72:73], v[218:219], 0
    s_waitcnt vmcnt(13)
    s_mov_b32 exec_lo, 0
    ds_write_b64 v84, v[64:65] offset:4352
    s_mov_b32 exec_lo, -1
    v_cvt_pk_bf16_f32 v68, v60, v61
    v_cvt_pk_bf16_f32 v69, v62, v63
    v_mfma_f32_16x16x16_bf16 v[56:59], v[72:73], v[220:221], 0
    v_cvt_pk_bf16_f32 v70, v8, v9
    v_cvt_pk_bf16_f32 v71, v10, v11
    v_mfma_f32_16x16x16_bf16 v[60:63], v[72:73], v[222:223], 0
    s_waitcnt vmcnt(12)
    v_cvt_pk_bf16_f32 v16, v12, v13
    v_cvt_pk_bf16_f32 v17, v14, v15
    s_cmp_eq_u32 s20, 0
    s_cselect_b64 s[100:101], s[98:99], 0
    v_add_u32 v84, 91648, v82
    v_cndmask_b32 v84, v82, v84, s[100:101]
    v_mfma_f32_16x16x16_bf16 v[8:11], v[72:73], v[224:225], 0
    v_cmp_ne_u64 vcc, s[36:37], v[44:45]
    s_nop 1
    s_and_b64 vcc, vcc, s[42:43]
    s_cbranch_scc1 SPINA
GOA:
    s_waitcnt lgkmcnt(0)
    s_barrier
    buffer_store_dwordx2 v[46:47], v50, s[16:19], 0 offen sc0 sc1
    ds_write_b128 v84, v[68:71] offset:0
    v_cvt_pk_bf16_f32 v18, v52, v53
    v_cvt_pk_bf16_f32 v19, v54, v55
    v_mfma_f32_16x16x16_bf16 v[12:15], v[72:73], v[226:227], 0
    s_waitcnt vmcnt(12)
    ds_write_b128 v84, v[16:19] offset:544
    v_cvt_pk_bf16_f32 v20, v56, v57
    v_cvt_pk_bf16_f32 v21, v58, v59
    v_mfma_f32_16x16x16_bf16 v[52:55], v[72:73], v[228:229], 0
    ds_read_b128 v[200:203], v85 offset:34816
    v_cvt_pk_bf16_f32 v22, v60, v61
    v_cvt_pk_bf16_f32 v23, v62, v63
    v_mfma_f32_16x16x16_bf16 v[56:59], v[72:73], v[230:231], 0
    s_waitcnt vmcnt(11)
    ds_write_b128 v84, v[20:23] offset:1088
    v_cvt_pk_bf16_f32 v64, v8, v9
    v_cvt_pk_bf16_f32 v65, v10, v11
    v_mfma_f32_16x16x16_bf16 v[60:63], v[72:73], v[232:233], 0
    ds_read_b128 v[204:207], v85 offset:43520
    v_cvt_pk_bf16_f32 v66, v12, v13
    v_cvt_pk_bf16_f32 v67, v14, v15
    v_mfma_f32_16x16x16_bf16 v[8:11], v[72:73], v[234:235], 0
    s_waitcnt vmcnt(10)
    buffer_load_dwordx4 v[88:91], v0, s[12:15], s22 offen offset:0 sc1
    ds_write_b128 v84, v[64:67] offset:1632
    v_cvt_pk_bf16_f32 v68, v52, v53
    v_cvt_pk_bf16_f32 v69, v54, v55
    v_mfma_f32_16x16x16_bf16 v[12:15], v[72:73], v[236:237], 0
    ds_read_b128 v[208:211], v85 offset:47872
    v_cvt_pk_bf16_f32 v70, v56, v57
    v_cvt_pk_bf16_f32 v71, v58, v59
    v_mfma_f32_16x16x16_bf16 v[52:55], v[72:73], v[238:239], 0
    s_waitcnt vmcnt(10)
    ds_write_b128 v84, v[68:71] offset:2176
    v_cvt_pk_bf16_f32 v16, v60, v61
    v_cvt_pk_bf16_f32 v17, v62, v63
    v_mfma_f32_16x16x16_bf16 v[56:59], v[72:73], v[240:241], 0
    v_cvt_pk_bf16_f32 v18, v8, v9
    v_cvt_pk_bf16_f32 v19, v10, v11
    v_mfma_f32_16x16x16_bf16 v[60:63], v[72:73], v[242:243], 0
    buffer_load_dwordx4 v[92:95], v0, s[12:15], s22 offen offset:1024 sc1
    ds_write_b128 v84, v[16:19] offset:2720
    v_cvt_pk_bf16_f32 v20, v12, v13
    v_cvt_pk_bf16_f32 v21, v14, v15
    v_mfma_f32_16x16x32_bf16 v[8:11], v[74:77], v[212:215], 0
    v_cvt_pk_bf16_f32 v22, v52, v53
    v_cvt_pk_bf16_f32 v23, v54, v55
    v_mfma_f32_16x16x32_bf16 v[8:11], v[78:81], v[216:219], v[8:11]
    ds_write_b128 v84, v[20:23] offset:3264
    v_cvt_pk_bf16_f32 v64, v56, v57
    v_cvt_pk_bf16_f32 v65, v58, v59
    v_mfma_f32_16x16x32_bf16 v[12:15], v[74:77], v[216:219], 0
    v_cvt_pk_bf16_f32 v66, v60, v61
    v_cvt_pk_bf16_f32 v67, v62, v63
    v_mfma_f32_16x16x32_bf16 v[12:15], v[78:81], v[220:223], v[12:15]
    buffer_load_dwordx4 v[96:99], v0, s[12:15], s22 offen offset:2048 sc1
    ds_write_b128 v84, v[64:67] offset:3808
    v_mfma_f32_16x16x32_bf16 v[52:55], v[74:77], v[220:223], 0
    v_cvt_pk_bf16_f32 v68, v8, v9
    v_cvt_pk_bf16_f32 v69, v10, v11
    v_mfma_f32_16x16x32_bf16 v[52:55], v[78:81], v[224:227], v[52:55]
    v_mfma_f32_16x16x32_bf16 v[56:59], v[74:77], v[224:227], 0
    s_waitcnt lgkmcnt(0)
    s_barrier
    ds_write_b64 v83, v[68:69] offset:31264
    v_cvt_pk_bf16_f32 v70, v12, v13
    v_cvt_pk_bf16_f32 v71, v14, v15
    v_mfma_f32_16x16x32_bf16 v[56:59], v[78:81], v[228:231], v[56:59]
    ds_read_b128 v[172:175], v85 offset:0
    buffer_load_dwordx4 v[100:103], v0, s[12:15], s22 offen offset:3072 sc1
    s_add_u32 s22, s22, 4096
    ds_write_b64 v83, v[70:71] offset:31808
    v_mfma_f32_16x16x32_bf16 v[60:63], v[74:77], v[228:231], 0
    ds_read_b128 v[176:179], v85 offset:4352
    v_cvt_pk_bf16_f32 v16, v52, v53
    v_cvt_pk_bf16_f32 v17, v54, v55
    v_mfma_f32_16x16x32_bf16 v[60:63], v[78:81], v[232:235], v[60:63]
    ds_read_b128 v[180:183], v86 offset:21760
    ds_write_b64 v83, v[16:17] offset:32352
    v_mfma_f32_16x16x32_bf16 v[8:11], v[74:77], v[232:235], 0
    ds_read_b128 v[184:187], v85 offset:8704
    v_cvt_pk_bf16_f32 v18, v56, v57
    v_cvt_pk_bf16_f32 v19, v58, v59
    v_mfma_f32_16x16x32_bf16 v[8:11], v[78:81], v[236:239], v[8:11]
    ds_read_b128 v[188:191], v86 offset:26112
    buffer_load_dwordx4 v[104:107], v0, s[12:15], s22 offen offset:0 sc1
    ds_write_b64 v83, v[18:19] offset:32896
    v_mfma_f32_16x16x32_bf16 v[12:15], v[74:77], v[236:239], 0
    ds_read_b128 v[192:195], v85 offset:13056
    v_cvt_pk_bf16_f32 v20, v60, v61
    v_cvt_pk_bf16_f32 v21, v62, v63
    v_mfma_f32_16x16x32_bf16 v[12:15], v[78:81], v[240:243], v[12:15]
    ds_read_b128 v[196:199], v86 offset:30464
    ds_write_b64 v83, v[20:21] offset:33440
    v_mfma_f32_16x16x32_bf16 v[52:55], v[78:81], v[212:215], 0
    v_cvt_pk_bf16_f32 v22, v8, v9
    v_cvt_pk_bf16_f32 v23, v10, v11
    v_mfma_f32_16x16x32_bf16 v[56:59], v[74:77], v[240:243], 0
    s_waitcnt vmcnt(13)
    buffer_load_dwordx4 v[108:111], v0, s[12:15], s22 offen offset:1024 sc1
    ds_write_b64 v83, v[22:23] offset:33984
    v_mfma_f32_16x16x16_bf16 v[60:63], v[72:73], v[244:245], 0
    v_cvt_pk_bf16_f32 v64, v12, v13
    v_cvt_pk_bf16_f32 v65, v14, v15
    v_mfma_f32_16x16x16_bf16 v[8:11], v[72:73], v[246:247], 0
    s_waitcnt vmcnt(13)
    ds_write_b64 v83, v[64:65] offset:34528
    v_cvt_pk_bf16_f32 v66, v52, v53
    v_cvt_pk_bf16_f32 v67, v54, v55
    v_mfma_f32_16x16x16_bf16 v[12:15], v[72:73], v[248:249], 0
    ds_read_b128 v[48:51], v4 offset:0
    s_mov_b32 exec_hi, 0
    ds_write_b64 v83, v[66:67] offset:30720
    s_mov_b32 exec_hi, -1
    v_cvt_pk_bf16_f32 v68, v56, v57
    v_cvt_pk_bf16_f32 v69, v58, v59
    v_mfma_f32_16x16x16_bf16 v[52:55], v[72:73], v[250:251], 0
    s_waitcnt vmcnt(12)
    s_mov_b32 exec_lo, 0
    ds_write_b64 v83, v[68:69] offset:35072
    s_mov_b32 exec_lo, -1
    v_cvt_pk_bf16_f32 v16, v60, v61
    v_cvt_pk_bf16_f32 v17, v62, v63
    v_mfma_f32_16x16x16_bf16 v[56:59], v[72:73], v[252:253], 0
    v_cvt_pk_bf16_f32 v18, v8, v9
    v_cvt_pk_bf16_f32 v19, v10, v11
    v_mfma_f32_16x16x16_bf16 v[60:63], v[72:73], v[254:255], 0
    s_waitcnt vmcnt(11)
    buffer_load_dwordx4 v[112:115], v0, s[12:15], s22 offen offset:2048 sc1
    v_cvt_pk_bf16_f32 v20, v12, v13
    v_cvt_pk_bf16_f32 v21, v14, v15
    v_mfma_f32_16x16x16_bf16 v[8:11], v[72:73], v[24:25], 0
    s_waitcnt lgkmcnt(0)
    s_barrier
    s_cmp_eq_u32 s20, 0
    s_cselect_b64 s[96:97], 1, 0
    ds_write_b128 v82, v[16:19] offset:0
    v_cvt_pk_bf16_f32 v22, v52, v53
    v_cvt_pk_bf16_f32 v23, v54, v55
    v_mfma_f32_16x16x16_bf16 v[12:15], v[72:73], v[26:27], 0
    s_waitcnt vmcnt(11)
    buffer_load_dwordx4 v[116:119], v0, s[12:15], s22 offen offset:3072 sc1
    s_add_u32 s22, s22, 4096
    ds_write_b128 v82, v[20:23] offset:544
    v_cvt_pk_bf16_f32 v64, v56, v57
    v_cvt_pk_bf16_f32 v65, v58, v59
    v_mfma_f32_16x16x16_bf16 v[52:55], v[72:73], v[28:29], 0
    v_cvt_pk_bf16_f32 v66, v60, v61
    v_cvt_pk_bf16_f32 v67, v62, v63
    v_mfma_f32_16x16x16_bf16 v[56:59], v[72:73], v[30:31], 0
    s_waitcnt vmcnt(11)
    ds_write_b128 v82, v[64:67] offset:1088
    v_cvt_pk_bf16_f32 v68, v8, v9
    v_cvt_pk_bf16_f32 v69, v10, v11
    v_mfma_f32_16x16x16_bf16 v[60:63], v[72:73], v[32:33], 0
    buffer_load_dwordx4 v[120:123], v0, s[12:15], s22 offen offset:0 sc1
    v_cvt_pk_bf16_f32 v70, v12, v13
    v_cvt_pk_bf16_f32 v71, v14, v15
    v_mfma_f32_16x16x16_bf16 v[8:11], v[72:73], v[34:35], 0
    s_waitcnt vmcnt(11)
    ds_write_b128 v82, v[68:71] offset:1632
    v_cvt_pk_bf16_f32 v16, v52, v53
    v_cvt_pk_bf16_f32 v17, v54, v55
    v_mfma_f32_16x16x16_bf16 v[12:15], v[72:73], v[36:37], 0
    v_cvt_pk_bf16_f32 v18, v56, v57
    v_cvt_pk_bf16_f32 v19, v58, v59
    v_mfma_f32_16x16x16_bf16 v[52:55], v[72:73], v[38:39], 0
    s_waitcnt vmcnt(10)
    buffer_load_dwordx4 v[124:127], v0, s[12:15], s22 offen offset:1024 sc1
    ds_write_b128 v82, v[16:19] offset:2176
    v_cvt_pk_bf16_f32 v20, v60, v61
    v_cvt_pk_bf16_f32 v21, v62, v63
    v_mfma_f32_16x16x16_bf16 v[56:59], v[72:73], v[40:41], 0
    v_cvt_pk_bf16_f32 v22, v8, v9
    v_cvt_pk_bf16_f32 v23, v10, v11
    v_mfma_f32_16x16x16_bf16 v[60:63], v[72:73], v[42:43], 0
    s_waitcnt vmcnt(9)
    buffer_load_dwordx4 v[128:131], v0, s[12:15], s22 offen offset:2048 sc1
    ds_write_b128 v82, v[20:23] offset:2720
    v_cvt_pk_bf16_f32 v64, v12, v13
    v_cvt_pk_bf16_f32 v65, v14, v15
    v_mfma_f32_16x16x32_bf16 v[8:11], v[88:91], a[0:3], v[48:51]
    s_waitcnt vmcnt(9)
    v_cvt_pk_bf16_f32 v66, v52, v53
    v_cvt_pk_bf16_f32 v67, v54, v55
    v_mfma_f32_16x16x32_bf16 v[8:11], v[92:95], a[4:7], v[8:11]
    s_waitcnt vmcnt(8)
    buffer_load_dwordx4 v[132:135], v0, s[12:15], s22 offen offset:3072 sc1
    v_mfma_f32_16x16x32_bf16 v[8:11], v[96:99], a[32:35], v[8:11]
    s_add_u32 s22, s22, 4096
    ds_write_b128 v82, v[64:67] offset:3264
    v_mfma_f32_16x16x32_bf16 v[52:55], v[74:77], v[244:247], 0
    v_cvt_pk_bf16_f32 v68, v56, v57
    v_cvt_pk_bf16_f32 v69, v58, v59
    v_mfma_f32_16x16x32_bf16 v[12:15], v[88:91], a[8:11], v[48:51]
    v_cvt_pk_bf16_f32 v70, v60, v61
    v_cvt_pk_bf16_f32 v71, v62, v63
    v_mfma_f32_16x16x32_bf16 v[12:15], v[92:95], a[12:15], v[12:15]
    ds_write_b128 v82, v[68:71] offset:3808
    v_mfma_f32_16x16x32_bf16 v[12:15], v[96:99], a[40:43], v[12:15]
    buffer_load_dwordx4 v[136:139], v0, s[12:15], s22 offen offset:0 sc1
    v_mfma_f32_16x16x32_bf16 v[52:55], v[78:81], v[248:251], v[52:55]
    v_mfma_f32_16x16x32_bf16 v[16:19], v[88:91], a[16:19], v[48:51]
    v_mfma_f32_16x16x32_bf16 v[16:19], v[92:95], a[20:23], v[16:19]
    v_mfma_f32_16x16x32_bf16 v[16:19], v[96:99], a[48:51], v[16:19]
    v_mfma_f32_16x16x32_bf16 v[56:59], v[74:77], v[248:251], 0
    v_mfma_f32_16x16x32_bf16 v[20:23], v[88:91], a[24:27], v[48:51]
    buffer_load_dwordx4 v[140:143], v0, s[12:15], s22 offen offset:1024 sc1
    v_mfma_f32_16x16x32_bf16 v[20:23], v[92:95], a[28:31], v[20:23]
    ds_read_b128 v[48:51], v5 offset:26112
    v_mfma_f32_16x16x32_bf16 v[20:23], v[96:99], a[56:59], v[20:23]
    s_waitcnt lgkmcnt(1)
    s_barrier
    v_mfma_f32_16x16x32_bf16 v[56:59], v[78:81], v[252:255], v[56:59]
    s_waitcnt vmcnt(10)
    v_cvt_pk_bf16_f32 v64, v52, v53
    v_cvt_pk_bf16_f32 v65, v54, v55
    v_mfma_f32_16x16x32_bf16 v[8:11], v[100:103], a[36:39], v[8:11]
    s_waitcnt vmcnt(9)
    ds_write_b64 v83, v[64:65] offset:544
    v_mfma_f32_16x16x32_bf16 v[8:11], v[104:107], a[76:79], v[8:11]
    s_waitcnt vmcnt(8)
    buffer_load_dwordx4 v[88:91], v0, s[12:15], s22 offen offset:2048 sc1
    ds_read_b128 v[212:215], v85 offset:0
    v_mfma_f32_16x16x32_bf16 v[8:11], v[108:111], a[80:83], v[8:11]
    v_mfma_f32_16x16x32_bf16 v[60:63], v[74:77], v[252:255], 0
    ds_read_b128 v[216:219], v86 offset:17408
    v_mfma_f32_16x16x32_bf16 v[12:15], v[100:103], a[44:47], v[12:15]
    v_mfma_f32_16x16x32_bf16 v[12:15], v[104:107], a[84:87], v[12:15]
    v_cvt_pk_bf16_f32 v66, v56, v57
    v_cvt_pk_bf16_f32 v67, v58, v59
    v_mfma_f32_16x16x32_bf16 v[12:15], v[108:111], a[88:91], v[12:15]
    buffer_load_dwordx4 v[92:95], v0, s[12:15], s22 offen offset:3072 sc1
    v_mfma_f32_16x16x32_bf16 v[60:63], v[78:81], v[24:27], v[60:63]
    ds_write_b64 v83, v[66:67] offset:1088
    v_mfma_f32_16x16x32_bf16 v[16:19], v[100:103], a[52:55], v[16:19]
    s_waitcnt lgkmcnt(4)
    ds_read_b128 v[220:223], v85 offset:4352
    v_mfma_f32_16x16x32_bf16 v[16:19], v[104:107], v[48:51], v[16:19]
    s_add_u32 s22, s22, 4096
    v_mfma_f32_16x16x32_bf16 v[16:19], v[108:111], a[92:95], v[16:19]
    ds_read_b128 v[48:51], v5 offset:30464
    v_mfma_f32_16x16x32_bf16 v[52:55], v[74:77], v[24:27], 0
    ds_read_b128 v[224:227], v86 offset:21760
    v_mfma_f32_16x16x32_bf16 v[20:23], v[100:103], a[60:63], v[20:23]
    buffer_load_dwordx4 v[96:99], v0, s[12:15], s22 offen offset:0 sc1
    v_mfma_f32_16x16x32_bf16 v[20:23], v[104:107], a[96:99], v[20:23]
    v_cvt_pk_bf16_f32 v68, v60, v61
    v_cvt_pk_bf16_f32 v69, v62, v63
    v_mfma_f32_16x16x32_bf16 v[20:23], v[108:111], a[100:103], v[20:23]
    ds_write_b64 v83, v[68:69] offset:1632
    v_mfma_f32_16x16x32_bf16 v[52:55], v[78:81], v[28:31], v[52:55]
    s_waitcnt vmcnt(10)
    ds_read_b128 v[228:231], v85 offset:8704
    v_mfma_f32_16x16x32_bf16 v[8:11], v[112:115], a[116:119], v[8:11]
    s_waitcnt vmcnt(9)
    v_mfma_f32_16x16x32_bf16 v[8:11], v[116:119], a[120:123], v[8:11]
    s_waitcnt vmcnt(8)
    buffer_load_dwordx4 v[100:103], v0, s[12:15], s22 offen offset:1024 sc1
    v_mfma_f32_16x16x32_bf16 v[8:11], v[120:123], a[164:167], v[8:11]
    v_mfma_f32_16x16x32_bf16 v[56:59], v[74:77], v[28:31], 0
    ds_read_b128 v[232:235], v86 offset:26112
    v_mfma_f32_16x16x32_bf16 v[12:15], v[112:115], a[124:127], v[12:15]
    v_mfma_f32_16x16x32_bf16 v[12:15], v[116:119], a[128:131], v[12:15]
    s_waitcnt lgkmcnt(4)
    v_cvt_pk_bf16_f32 v70, v52, v53
    v_cvt_pk_bf16_f32 v71, v54, v55
    v_mfma_f32_16x16x32_bf16 v[12:15], v[120:123], v[48:51], v[12:15]
    buffer_load_dwordx4 v[104:107], v0, s[12:15], s22 offen offset:2048 sc1
    v_mfma_f32_16x16x32_bf16 v[56:59], v[78:81], v[32:35], v[56:59]
    ds_write_b64 v83, v[70:71] offset:2176
    v_mfma_f32_16x16x32_bf16 v[16:19], v[112:115], a[132:135], v[16:19]
    ds_read_b128 v[236:239], v85 offset:13056
    v_mfma_f32_16x16x32_bf16 v[16:19], v[116:119], a[136:139], v[16:19]
    ds_read_b128 v[48:51], v5 offset:34816
    v_mfma_f32_16x16x32_bf16 v[16:19], v[120:123], a[176:179], v[16:19]
    v_mfma_f32_16x16x32_bf16 v[60:63], v[74:77], v[32:35], 0
    ds_read_b128 v[240:243], v86 offset:30464
    v_mfma_f32_16x16x32_bf16 v[20:23], v[112:115], a[140:143], v[20:23]
    buffer_load_dwordx4 v[108:111], v0, s[12:15], s22 offen offset:3072 sc1
    v_mfma_f32_16x16x32_bf16 v[20:23], v[116:119], a[144:147], v[20:23]
    s_add_u32 s22, s22, 4096
    v_cvt_pk_bf16_f32 v64, v56, v57
    v_cvt_pk_bf16_f32 v65, v58, v59
    v_mfma_f32_16x16x32_bf16 v[20:23], v[120:123], a[184:187], v[20:23]
    ds_write_b64 v83, v[64:65] offset:2720
    v_mfma_f32_16x16x32_bf16 v[60:63], v[78:81], v[36:39], v[60:63]
    s_waitcnt vmcnt(10)
    v_mfma_f32_16x16x32_bf16 v[8:11], v[124:127], a[168:171], v[8:11]
    s_waitcnt vmcnt(9)
    v_mfma_f32_16x16x32_bf16 v[8:11], v[128:131], a[204:207], v[8:11]
    s_waitcnt vmcnt(8)
    buffer_load_dwordx4 v[112:115], v0, s[12:15], s22 offen offset:0 sc1
    v_mfma_f32_16x16x32_bf16 v[8:11], v[132:135], a[208:211], v[8:11]
    v_mfma_f32_16x16x32_bf16 v[52:55], v[74:77], v[36:39], 0
    v_mfma_f32_16x16x32_bf16 v[12:15], v[124:127], a[172:175], v[12:15]
    s_waitcnt lgkmcnt(2)
    v_mfma_f32_16x16x32_bf16 v[12:15], v[128:131], v[48:51], v[12:15]
    ds_read_b128 v[48:51], v6 offset:39168
    buffer_load_dwordx2 v[72:73], v87, s[16:19], 0 offen sc1
    v_mfma_f32_16x16x32_bf16 v[12:15], v[132:135], a[212:215], v[12:15]
    buffer_load_dwordx4 v[116:119], v0, s[12:15], s22 offen offset:1024 sc1
    v_mfma_f32_16x16x32_bf16 v[52:55], v[78:81], v[40:43], v[52:55]
    v_cvt_pk_bf16_f32 v66, v60, v61
    v_cvt_pk_bf16_f32 v67, v62, v63
    v_mfma_f32_16x16x32_bf16 v[16:19], v[124:127], a[180:183], v[16:19]
    ds_write_b64 v83, v[66:67] offset:3264
    v_mfma_f32_16x16x32_bf16 v[16:19], v[128:131], a[216:219], v[16:19]
    v_mfma_f32_16x16x32_bf16 v[16:19], v[132:135], a[220:223], v[16:19]
    v_mfma_f32_16x16x32_bf16 v[56:59], v[78:81], v[244:247], 0
    v_mfma_f32_16x16x32_bf16 v[20:23], v[124:127], a[188:191], v[20:23]
    buffer_load_dwordx4 v[120:123], v0, s[12:15], s22 offen offset:2048 sc1
    v_mfma_f32_16x16x32_bf16 v[20:23], v[128:131], a[224:227], v[20:23]
    v_cvt_pk_bf16_f32 v68, v52, v53
    v_cvt_pk_bf16_f32 v69, v54, v55
    v_mfma_f32_16x16x32_bf16 v[20:23], v[132:135], a[228:231], v[20:23]
    ds_write_b64 v83, v[68:69] offset:3808
    v_mfma_f32_16x16x32_bf16 v[60:63], v[74:77], v[40:43], 0
    s_waitcnt vmcnt(11)
    v_mfma_f32_16x16x32_bf16 v[8:11], v[136:139], a[240:243], v[8:11]
    s_waitcnt vmcnt(10) lgkmcnt(2)
    v_mfma_f32_16x16x32_bf16 v[8:11], v[140:143], v[48:51], v[8:11]
    s_waitcnt vmcnt(9)
    buffer_load_dwordx4 v[124:127], v0, s[12:15], s22 offen offset:3072 sc1
    v_mfma_f32_16x16x32_bf16 v[8:11], v[88:91], v[172:175], v[8:11]
    s_add_u32 s22, s22, 4096
    v_cvt_pk_bf16_f32 v70, v56, v57
    v_cvt_pk_bf16_f32 v71, v58, v59
    v_mfma_f32_16x16x32_bf16 v[12:15], v[136:139], a[244:247], v[12:15]
    ds_read_b128 v[48:51], v6 offset:43520
    ds_read_b128 v[244:247], v5 offset:0
    v_mfma_f32_16x16x32_bf16 v[12:15], v[140:143], a[248:251], v[12:15]
    s_mov_b32 exec_hi, 0
    ds_write_b64 v83, v[70:71] offset:0
    s_mov_b32 exec_hi, -1
    v_mfma_f32_16x16x32_bf16 v[12:15], v[88:91], v[176:179], v[12:15]
    buffer_load_dwordx4 v[128:131], v0, s[12:15], s22 offen offset:0 sc1
    v_mfma_f32_16x16x32_bf16 v[16:19], v[136:139], a[252:255], v[16:19]
    v_cvt_pk_bf16_f32 v64, v60, v61
    v_cvt_pk_bf16_f32 v65, v62, v63
    v_mfma_f32_16x16x32_bf16 v[16:19], v[140:143], v[144:147], v[16:19]
    s_mov_b32 exec_lo, 0
    ds_write_b64 v83, v[64:65] offset:4352
    s_mov_b32 exec_lo, -1
    v_mfma_f32_16x16x32_bf16 v[16:19], v[88:91], v[184:187], v[16:19]
    ds_read_b128 v[248:251], v5 offset:4352
    v_mfma_f32_16x16x32_bf16 v[20:23], v[136:139], v[148:151], v[20:23]
    buffer_load_dwordx4 v[132:135], v0, s[12:15], s22 offen offset:1024 sc1
    v_mfma_f32_16x16x32_bf16 v[20:23], v[140:143], v[152:155], v[20:23]
    ds_read_b128 v[252:255], v5 offset:8704
    v_mfma_f32_16x16x32_bf16 v[20:23], v[88:91], v[192:195], v[20:23]
    s_waitcnt vmcnt(11) lgkmcnt(5)
    v_mfma_f32_16x16x32_bf16 v[8:11], v[92:95], v[48:51], v[8:11]
    s_waitcnt vmcnt(10)
    v_mfma_f32_16x16x32_bf16 v[8:11], v[96:99], v[212:215], v[8:11]
    s_waitcnt vmcnt(9)
    buffer_load_dwordx4 v[136:139], v0, s[12:15], s22 offen offset:2048 sc1
    v_mfma_f32_16x16x32_bf16 v[8:11], v[100:103], v[216:219], v[8:11]
    ds_read_b128 v[24:27], v5 offset:13056
    v_mfma_f32_16x16x32_bf16 v[12:15], v[92:95], v[180:183], v[12:15]
    ds_read_b128 v[48:51], v5 offset:47872
    v_mfma_f32_16x16x32_bf16 v[12:15], v[96:99], v[220:223], v[12:15]
    v_mfma_f32_16x16x32_bf16 v[12:15], v[100:103], v[224:227], v[12:15]
    buffer_load_dwordx4 v[88:91], v0, s[12:15], s22 offen offset:3072 sc1
    v_mfma_f32_16x16x32_bf16 v[16:19], v[92:95], v[188:191], v[16:19]
    s_waitcnt lgkmcnt(1)
    s_add_u32 s22, s22, 4096
    s_barrier
    v_mfma_f32_16x16x32_bf16 v[16:19], v[96:99], v[228:231], v[16:19]
    ds_read_b128 v[28:31], v85 offset:34816
    v_mfma_f32_16x16x32_bf16 v[16:19], v[100:103], v[232:235], v[16:19]
    ds_write_b128 v2, v[8:11] offset:0
    v_mfma_f32_16x16x32_bf16 v[20:23], v[92:95], v[196:199], v[20:23]
    buffer_load_dwordx4 v[92:95], v0, s[12:15], s22 offen offset:0 sc1
    v_mfma_f32_16x16x32_bf16 v[20:23], v[96:99], v[236:239], v[20:23]
    v_mfma_f32_16x16x32_bf16 v[20:23], v[100:103], v[240:243], v[20:23]
    s_waitcnt vmcnt(11) lgkmcnt(2)
    ds_read_b128 v[32:35], v85 offset:39168
    v_mfma_f32_16x16x32_bf16 v[8:11], v[104:107], v[48:51], 0
    s_waitcnt vmcnt(10)
    ds_write_b128 v2, v[12:15] offset:8192
    v_mfma_f32_16x16x32_bf16 v[8:11], v[108:111], a[104:107], v[8:11]
    s_waitcnt vmcnt(9)
    buffer_load_dwordx4 v[96:99], v0, s[12:15], s22 offen offset:1024 sc1
    v_mfma_f32_16x16x32_bf16 v[8:11], v[112:115], a[148:151], v[8:11]
    ds_read_b128 v[48:51], v5 offset:52224
    ds_read_b128 v[68:71], v5 offset:17408
    v_mfma_f32_16x16x32_bf16 v[12:15], v[104:107], a[64:67], 0
    ds_read_b128 v[36:39], v85 offset:43520
    v_mfma_f32_16x16x32_bf16 v[12:15], v[108:111], a[108:111], v[12:15]
    ds_write_b128 v2, v[16:19] offset:16384
    v_mfma_f32_16x16x32_bf16 v[12:15], v[112:115], a[152:155], v[12:15]
    buffer_load_dwordx4 v[100:103], v0, s[12:15], s22 offen offset:2048 sc1
    v_mfma_f32_16x16x32_bf16 v[16:19], v[104:107], a[68:71], 0
    ds_read_b128 v[44:47], v5 offset:21760
    v_mfma_f32_16x16x32_bf16 v[16:19], v[108:111], a[112:115], v[16:19]
    ds_write_b128 v2, v[20:23] offset:24576
    v_mfma_f32_16x16x32_bf16 v[16:19], v[112:115], a[156:159], v[16:19]
    ds_read_b128 v[40:43], v85 offset:47872
    v_mfma_f32_16x16x32_bf16 v[20:23], v[104:107], a[72:75], 0
    s_waitcnt lgkmcnt(6)
    buffer_load_dwordx4 v[104:107], v0, s[12:15], s22 offen offset:3072 sc1
    v_mfma_f32_16x16x32_bf16 v[20:23], v[108:111], v[48:51], v[20:23]
    s_add_u32 s22, s22, 4096
    ds_read_b128 v[48:51], v5 offset:56576
    v_mfma_f32_16x16x32_bf16 v[20:23], v[112:115], a[160:163], v[20:23]
    s_waitcnt vmcnt(10)
    v_mfma_f32_16x16x32_bf16 v[8:11], v[116:119], a[192:195], v[8:11]
    s_waitcnt vmcnt(9)
    v_mfma_f32_16x16x32_bf16 v[8:11], v[120:123], a[232:235], v[8:11]
    s_waitcnt vmcnt(8)
    buffer_load_dwordx4 v[108:111], v0, s[12:15], s22 offen offset:0 sc1
    v_mfma_f32_16x16x32_bf16 v[8:11], v[124:127], v[156:159], v[8:11]
    v_mfma_f32_16x16x32_bf16 v[12:15], v[116:119], a[196:199], v[12:15]
    v_mfma_f32_16x16x32_bf16 v[12:15], v[120:123], a[236:239], v[12:15]
    v_mfma_f32_16x16x32_bf16 v[12:15], v[124:127], v[160:163], v[12:15]
    s_waitcnt lgkmcnt(0)
    buffer_load_dwordx4 v[112:115], v0, s[12:15], s22 offen offset:1024 sc1
    v_mfma_f32_16x16x32_bf16 v[16:19], v[116:119], v[48:51], v[16:19]
    ds_read_b128 v[48:51], v5 offset:60928
    v_mfma_f32_16x16x32_bf16 v[16:19], v[120:123], v[68:71], v[16:19]
    v_mfma_f32_16x16x32_bf16 v[16:19], v[124:127], v[164:167], v[16:19]
    v_mfma_f32_16x16x32_bf16 v[20:23], v[116:119], a[200:203], v[20:23]
    buffer_load_dwordx4 v[116:119], v0, s[12:15], s22 offen offset:2048 sc1
    v_mfma_f32_16x16x32_bf16 v[20:23], v[120:123], v[44:47], v[20:23]
    v_mfma_f32_16x16x32_bf16 v[20:23], v[124:127], v[168:171], v[20:23]
    s_waitcnt vmcnt(10)
    v_mfma_f32_16x16x32_bf16 v[8:11], v[128:131], v[200:203], v[8:11]
    s_waitcnt vmcnt(9)
    v_mfma_f32_16x16x32_bf16 v[8:11], v[132:135], v[244:247], v[8:11]
    s_waitcnt vmcnt(8)
    buffer_load_dwordx4 v[120:123], v0, s[12:15], s22 offen offset:3072 sc1
    v_mfma_f32_16x16x32_bf16 v[8:11], v[136:139], v[28:31], v[8:11]
    s_waitcnt lgkmcnt(0)
    v_mfma_f32_16x16x32_bf16 v[12:15], v[128:131], v[48:51], v[12:15]
    s_add_u32 s22, s22, 4096
    ds_read_b128 v[48:51], v4 offset:16
    v_mfma_f32_16x16x32_bf16 v[12:15], v[132:135], v[248:251], v[12:15]
    v_mfma_f32_16x16x32_bf16 v[12:15], v[136:139], v[32:35], v[12:15]
    buffer_load_dwordx4 v[124:127], v0, s[12:15], s22 offen offset:0 sc1
    v_mfma_f32_16x16x32_bf16 v[16:19], v[128:131], v[204:207], v[16:19]
    v_mfma_f32_16x16x32_bf16 v[16:19], v[132:135], v[252:255], v[16:19]
    ds_write_b128 v2, v[8:11] offset:1024
    v_mfma_f32_16x16x32_bf16 v[16:19], v[136:139], v[36:39], v[16:19]
    v_mfma_f32_16x16x32_bf16 v[20:23], v[128:131], v[208:211], v[20:23]
    buffer_load_dwordx4 v[128:131], v0, s[12:15], s22 offen offset:1024 sc1
    v_mfma_f32_16x16x32_bf16 v[20:23], v[132:135], v[24:27], v[20:23]
    v_cmp_ne_u64 vcc, s[36:37], v[72:73]
    s_nop 1
    s_and_b64 vcc, vcc, s[96:97]
    s_cbranch_scc1 SPINB
GOB:
    v_mfma_f32_16x16x32_bf16 v[20:23], v[136:139], v[40:43], v[20:23]
    s_waitcnt vmcnt(10) lgkmcnt(1)
    ds_write_b128 v2, v[12:15] offset:9216
LOOP:
    v_mfma_f32_16x16x32_bf16 v[8:11], v[88:91], a[0:3], v[48:51]
    s_waitcnt vmcnt(9)
    v_rcp_f32 v74, v74
    v_mfma_f32_16x16x32_bf16 v[8:11], v[92:95], a[4:7], v[8:11]
    s_waitcnt vmcnt(8)
    buffer_load_dwordx4 v[132:135], v0, s[12:15], s22 offen offset:2048 sc1
    v_fma_f32 v75, v75, s28, s28
    v_mfma_f32_16x16x32_bf16 v[8:11], v[96:99], a[32:35], v[8:11]
    v_rcp_f32 v75, v75
    v_mfma_f32_16x16x32_bf16 v[12:15], v[88:91], a[8:11], v[48:51]
    ds_write_b128 v2, v[16:19] offset:17408
    v_mfma_f32_16x16x32_bf16 v[12:15], v[92:95], a[12:15], v[12:15]
    v_fma_f32 v82, v82, s28, s28
    v_fma_f32 v83, v83, s28, s28
    v_mfma_f32_16x16x32_bf16 v[12:15], v[96:99], a[40:43], v[12:15]
    buffer_load_dwordx4 v[136:139], v0, s[12:15], s22 offen offset:3072 sc1
    v_mfma_f32_16x16x32_bf16 v[16:19], v[88:91], a[16:19], v[48:51]
    s_add_u32 s22, s22, 4096
    v_rcp_f32 v82, v82
    v_mfma_f32_16x16x32_bf16 v[16:19], v[92:95], a[20:23], v[16:19]
    ds_write_b128 v2, v[20:23] offset:25600
    v_mfma_f32_16x16x32_bf16 v[16:19], v[96:99], a[48:51], v[16:19]
    v_rcp_f32 v83, v83
    v_mfma_f32_16x16x32_bf16 v[20:23], v[88:91], a[24:27], v[48:51]
    buffer_load_dwordx4 v[140:143], v0, s[12:15], s22 offen offset:0 sc1
    v_mfma_f32_16x16x32_bf16 v[20:23], v[92:95], a[28:31], v[20:23]
    ds_read_b128 v[48:51], v5 offset:26112
    v_mfma_f32_16x16x32_bf16 v[20:23], v[96:99], a[56:59], v[20:23]
    s_waitcnt vmcnt(10) lgkmcnt(1)
    s_barrier
    v_mfma_f32_16x16x32_bf16 v[8:11], v[100:103], a[36:39], v[8:11]
    s_waitcnt vmcnt(9)
    ds_read_b128 v[56:59], v3 offset:2048
    ds_read_b128 v[52:55], v3 offset:0
    v_mfma_f32_16x16x32_bf16 v[8:11], v[104:107], a[76:79], v[8:11]
    s_waitcnt vmcnt(8)
    buffer_load_dwordx4 v[88:91], v0, s[12:15], s22 offen offset:1024 sc1
    ds_read_b128 v[60:63], v3 offset:4096
    v_mfma_f32_16x16x32_bf16 v[8:11], v[108:111], a[80:83], v[8:11]
    v_mul_f32 v64, v64, v74
    v_mul_f32 v65, v65, v75
    v_mfma_f32_16x16x32_bf16 v[12:15], v[100:103], a[44:47], v[12:15]
    v_mul_f32 v66, v66, v82
    v_mul_f32 v67, v67, v83
    v_mfma_f32_16x16x32_bf16 v[12:15], v[104:107], a[84:87], v[12:15]
    v_cvt_pk_bf16_f32 v74, v64, v65
    v_cvt_pk_bf16_f32 v75, v66, v67
    v_mfma_f32_16x16x32_bf16 v[12:15], v[108:111], a[88:91], v[12:15]
    buffer_load_dwordx4 v[92:95], v0, s[12:15], s22 offen offset:2048 sc1
    ds_read_b128 v[64:67], v3 offset:6144
    v_mfma_f32_16x16x32_bf16 v[16:19], v[100:103], a[52:55], v[16:19]
    s_waitcnt lgkmcnt(2)
    buffer_store_dwordx4 v[72:75], v1, s[8:11], s24 offen offset:0 nt
    v_add_f32 v52, v52, v56
    v_add_f32 v53, v53, v57
    v_mfma_f32_16x16x32_bf16 v[16:19], v[104:107], v[48:51], v[16:19]
    v_add_f32 v54, v54, v58
    v_add_f32 v55, v55, v59
    v_mfma_f32_16x16x32_bf16 v[16:19], v[108:111], a[92:95], v[16:19]
    ds_read_b128 v[48:51], v5 offset:30464
    v_fma_f32 v56, -2.0, v56, v52
    v_mfma_f32_16x16x32_bf16 v[20:23], v[100:103], a[60:63], v[20:23]
    buffer_load_dwordx4 v[96:99], v0, s[12:15], s22 offen offset:3072 sc1
    v_fma_f32 v57, -2.0, v57, v53
    v_mfma_f32_16x16x32_bf16 v[20:23], v[104:107], a[96:99], v[20:23]
    s_add_u32 s22, s22, 4096
    v_fma_f32 v58, -2.0, v58, v54
    v_fma_f32 v59, -2.0, v59, v55
    v_mfma_f32_16x16x32_bf16 v[20:23], v[108:111], a[100:103], v[20:23]
    s_waitcnt vmcnt(11) lgkmcnt(1)
    v_sub_f32 v60, v60, v64
    v_sub_f32 v61, v61, v65
    v_mfma_f32_16x16x32_bf16 v[8:11], v[112:115], a[116:119], v[8:11]
    s_waitcnt vmcnt(10)
    v_sub_f32 v62, v62, v66
    v_sub_f32 v63, v63, v67
    v_mfma_f32_16x16x32_bf16 v[8:11], v[116:119], a[120:123], v[8:11]
    s_waitcnt vmcnt(9)
    buffer_load_dwordx4 v[100:103], v0, s[12:15], s22 offen offset:0 sc1
    v_fmac_f32 v56, s54, v60
    v_mfma_f32_16x16x32_bf16 v[8:11], v[120:123], a[164:167], v[8:11]
    v_exp_f32 v78, v56
    v_mfma_f32_16x16x32_bf16 v[12:15], v[112:115], a[124:127], v[12:15]
    v_fmac_f32 v57, s54, v61
    v_fmac_f32 v58, s54, v62
    v_mfma_f32_16x16x32_bf16 v[12:15], v[116:119], a[128:131], v[12:15]
    s_waitcnt lgkmcnt(0)
    v_fmac_f32 v59, s54, v63
    v_fma_f32 v64, 2.0, v64, v60
    v_mfma_f32_16x16x32_bf16 v[12:15], v[120:123], v[48:51], v[12:15]
    buffer_load_dwordx4 v[104:107], v0, s[12:15], s22 offen offset:1024 sc1
    v_fma_f32 v65, 2.0, v65, v61
    v_mfma_f32_16x16x32_bf16 v[16:19], v[112:115], a[132:135], v[16:19]
    s_lshr_b64 s[40:41], s[40:41], 4
    v_exp_f32 v79, v57
    v_mfma_f32_16x16x32_bf16 v[16:19], v[116:119], a[136:139], v[16:19]
    s_and_b32 s26, s40, 15
    ds_read_b128 v[48:51], v5 offset:34816
    v_fma_f32 v66, 2.0, v66, v62
    v_mfma_f32_16x16x32_bf16 v[16:19], v[120:123], a[176:179], v[16:19]
    s_mul_i32 s23, s26, 55296
    v_exp_f32 v86, v58
    v_mfma_f32_16x16x32_bf16 v[20:23], v[112:115], a[140:143], v[20:23]
    s_sub_u32 s27, s26, s25
    buffer_load_dwordx4 v[108:111], v0, s[12:15], s22 offen offset:2048 sc1
    v_fma_f32 v67, 2.0, v67, v63
    v_mfma_f32_16x16x32_bf16 v[20:23], v[116:119], a[144:147], v[20:23]
    s_lshl_b32 s27, s27, 7
    v_exp_f32 v87, v59
    v_mfma_f32_16x16x32_bf16 v[20:23], v[120:123], a[184:187], v[20:23]
    s_waitcnt vmcnt(11)
    v_fmac_f32 v60, s52, v56
    v_fmac_f32 v61, s52, v57
    v_mfma_f32_16x16x32_bf16 v[8:11], v[124:127], a[168:171], v[8:11]
    s_waitcnt vmcnt(10)
    v_fmac_f32 v62, s52, v58
    v_fmac_f32 v63, s52, v59
    v_mfma_f32_16x16x32_bf16 v[8:11], v[128:131], a[204:207], v[8:11]
    s_waitcnt vmcnt(9)
    buffer_load_dwordx4 v[112:115], v0, s[12:15], s22 offen offset:3072 sc1
    v_fmac_f32 v64, s57, v52
    v_mfma_f32_16x16x32_bf16 v[8:11], v[132:135], a[208:211], v[8:11]
    s_add_u32 s22, s22, 4096
    v_fmac_f32 v65, s57, v53
    v_fmac_f32 v66, s57, v54
    v_mfma_f32_16x16x32_bf16 v[12:15], v[124:127], a[172:175], v[12:15]
    s_waitcnt lgkmcnt(0)
    v_fmac_f32 v67, s57, v55
    v_fma_f32 v78, v78, s28, s28
    v_mfma_f32_16x16x32_bf16 v[12:15], v[128:131], v[48:51], v[12:15]
    ds_read_b128 v[48:51], v6 offset:39168
    v_fmac_f32 v52, s55, v64
    v_mfma_f32_16x16x32_bf16 v[12:15], v[132:135], a[212:215], v[12:15]
    buffer_load_dwordx4 v[116:119], v0, s[12:15], s22 offen offset:0 sc1
    v_fma_f32 v79, v79, s28, s28
    v_mfma_f32_16x16x32_bf16 v[16:19], v[124:127], a[180:183], v[16:19]
    v_rcp_f32 v78, v78
    v_mfma_f32_16x16x32_bf16 v[16:19], v[128:131], a[216:219], v[16:19]
    v_rcp_f32 v79, v79
    v_mfma_f32_16x16x32_bf16 v[16:19], v[132:135], a[220:223], v[16:19]
    v_fmac_f32 v53, s55, v65
    v_fma_f32 v86, v86, s28, s28
    v_mfma_f32_16x16x32_bf16 v[20:23], v[124:127], a[188:191], v[20:23]
    buffer_load_dwordx4 v[120:123], v0, s[12:15], s22 offen offset:1024 sc1
    v_fmac_f32 v54, s55, v66
    v_mfma_f32_16x16x32_bf16 v[20:23], v[128:131], a[224:227], v[20:23]
    v_fma_f32 v87, v87, s28, s28
    v_fmac_f32 v55, s55, v67
    v_mfma_f32_16x16x32_bf16 v[20:23], v[132:135], a[228:231], v[20:23]
    s_waitcnt vmcnt(11)
    v_rcp_f32 v86, v86
    v_mfma_f32_16x16x32_bf16 v[8:11], v[136:139], a[240:243], v[8:11]
    s_waitcnt vmcnt(10) lgkmcnt(0)
    v_rcp_f32 v87, v87
    v_mfma_f32_16x16x32_bf16 v[8:11], v[140:143], v[48:51], v[8:11]
    s_waitcnt vmcnt(9)
    buffer_load_dwordx4 v[124:127], v0, s[12:15], s22 offen offset:2048 sc1
    v_mul_f32 v56, v56, v78
    v_mfma_f32_16x16x32_bf16 v[8:11], v[88:91], v[172:175], v[8:11]
    s_lshl_b32 s24, s25, 6
    v_exp_f32 v82, v64
    v_mfma_f32_16x16x32_bf16 v[12:15], v[136:139], a[244:247], v[12:15]
    s_mov_b32 s25, s26
    ds_read_b128 v[48:51], v6 offset:43520
    v_mul_f32 v57, v57, v79
    v_mfma_f32_16x16x32_bf16 v[12:15], v[140:143], a[248:251], v[12:15]
    v_exp_f32 v83, v65
    v_mfma_f32_16x16x32_bf16 v[12:15], v[88:91], v[176:179], v[12:15]
    buffer_load_dwordx4 v[128:131], v0, s[12:15], s22 offen offset:3072 sc1
    v_mul_f32 v58, v58, v86
    v_mfma_f32_16x16x32_bf16 v[16:19], v[136:139], a[252:255], v[16:19]
    s_add_u32 s22, s22, 4096
    v_exp_f32 v74, v66
    v_mfma_f32_16x16x32_bf16 v[16:19], v[140:143], v[144:147], v[16:19]
    v_exp_f32 v75, v67
    v_mfma_f32_16x16x32_bf16 v[16:19], v[88:91], v[184:187], v[16:19]
    v_mul_f32 v59, v59, v87
    v_cvt_pk_bf16_f32 v76, v56, v57
    v_mfma_f32_16x16x32_bf16 v[20:23], v[136:139], v[148:151], v[20:23]
    buffer_load_dwordx4 v[132:135], v0, s[12:15], s22 offen offset:0 sc1
    v_cvt_pk_bf16_f32 v77, v58, v59
    v_mfma_f32_16x16x32_bf16 v[20:23], v[140:143], v[152:155], v[20:23]
    ds_read_b128 v[56:59], v3 offset:5120
    v_fma_f32 v82, v82, s28, s28
    v_mfma_f32_16x16x32_bf16 v[20:23], v[88:91], v[192:195], v[20:23]
    s_waitcnt vmcnt(11) lgkmcnt(1)
    v_rcp_f32 v82, v82
    v_mfma_f32_16x16x32_bf16 v[8:11], v[92:95], v[48:51], v[8:11]
    s_waitcnt vmcnt(9)
    v_fma_f32 v83, v83, s28, s28
    v_fma_f32 v74, v74, s28, s28
    v_mfma_f32_16x16x32_bf16 v[8:11], v[96:99], v[212:215], v[8:11]
    s_waitcnt vmcnt(8)
    buffer_load_dwordx4 v[136:139], v0, s[12:15], s22 offen offset:1024 sc1
    v_fma_f32 v75, v75, s28, s28
    v_mul_f32 v64, v64, v82
    v_mfma_f32_16x16x32_bf16 v[8:11], v[100:103], v[216:219], v[8:11]
    s_mov_b32 s22, s23
    v_rcp_f32 v83, v83
    v_mfma_f32_16x16x32_bf16 v[12:15], v[92:95], v[180:183], v[12:15]
    s_waitcnt lgkmcnt(0)
    ds_read_b128 v[48:51], v5 offset:47872
    v_fmac_f32 v56, s53, v60
    v_mfma_f32_16x16x32_bf16 v[12:15], v[96:99], v[220:223], v[12:15]
    v_fmac_f32 v57, s53, v61
    v_fmac_f32 v58, s53, v62
    v_fmac_f32 v59, s53, v63
    v_mfma_f32_16x16x32_bf16 v[12:15], v[100:103], v[224:227], v[12:15]
    buffer_load_dwordx4 v[88:91], v0, s[12:15], s22 offen offset:0 sc1
    ds_read_b128 v[60:63], v3 offset:7168
    v_mfma_f32_16x16x32_bf16 v[16:19], v[92:95], v[188:191], v[16:19]
    v_rcp_f32 v74, v74
    v_mul_f32 v65, v65, v83
    v_mfma_f32_16x16x32_bf16 v[16:19], v[96:99], v[228:231], v[16:19]
    v_rcp_f32 v75, v75
    v_mfma_f32_16x16x32_bf16 v[16:19], v[100:103], v[232:235], v[16:19]
    ds_write_b128 v2, v[8:11] offset:32768
    v_mfma_f32_16x16x32_bf16 v[20:23], v[92:95], v[196:199], v[20:23]
    buffer_load_dwordx4 v[92:95], v0, s[12:15], s22 offen offset:1024 sc1
    v_mul_f32 v66, v66, v74
    v_mfma_f32_16x16x32_bf16 v[20:23], v[96:99], v[236:239], v[20:23]
    v_mul_f32 v67, v67, v75
    v_cvt_pk_bf16_f32 v80, v64, v65
    v_mfma_f32_16x16x32_bf16 v[20:23], v[100:103], v[240:243], v[20:23]
    s_waitcnt vmcnt(10) lgkmcnt(1)
    v_cvt_pk_bf16_f32 v81, v66, v67
    v_add_f32 v56, v56, v60
    v_mfma_f32_16x16x32_bf16 v[8:11], v[104:107], v[48:51], 0
    s_waitcnt vmcnt(9)
    ds_write_b128 v2, v[12:15] offset:40960
    v_mfma_f32_16x16x32_bf16 v[8:11], v[108:111], a[104:107], v[8:11]
    s_waitcnt vmcnt(8)
    buffer_load_dwordx4 v[96:99], v0, s[12:15], s22 offen offset:2048 sc1
    ds_read_b128 v[64:67], v3 offset:1024
    v_mfma_f32_16x16x32_bf16 v[8:11], v[112:115], a[148:151], v[8:11]
    ds_read_b128 v[48:51], v5 offset:52224
    v_add_f32 v57, v57, v61
    v_mfma_f32_16x16x32_bf16 v[12:15], v[104:107], a[64:67], 0
    v_exp_f32 v86, v56
    v_mfma_f32_16x16x32_bf16 v[12:15], v[108:111], a[108:111], v[12:15]
    ds_write_b128 v2, v[16:19] offset:49152
    v_mfma_f32_16x16x32_bf16 v[12:15], v[112:115], a[152:155], v[12:15]
    buffer_load_dwordx4 v[100:103], v0, s[12:15], s22 offen offset:3072 sc1
    v_add_f32 v58, v58, v62
    v_mfma_f32_16x16x32_bf16 v[16:19], v[104:107], a[68:71], 0
    s_add_u32 s22, s22, 4096
    v_add_f32 v59, v59, v63
    v_fma_f32 v86, v86, s28, s28
    v_mfma_f32_16x16x32_bf16 v[16:19], v[108:111], a[112:115], v[16:19]
    ds_write_b128 v2, v[20:23] offset:57344
    v_mfma_f32_16x16x32_bf16 v[16:19], v[112:115], a[156:159], v[16:19]
    v_exp_f32 v87, v57
    v_mfma_f32_16x16x32_bf16 v[20:23], v[104:107], a[72:75], 0
    s_waitcnt lgkmcnt(2)
    buffer_load_dwordx4 v[104:107], v0, s[12:15], s22 offen offset:0 sc1
    v_fma_f32 v87, v87, s28, s28
    v_mfma_f32_16x16x32_bf16 v[20:23], v[108:111], v[48:51], v[20:23]
    ds_read_b128 v[48:51], v5 offset:56576
    v_fmac_f32 v64, s56, v52
    v_mfma_f32_16x16x32_bf16 v[20:23], v[112:115], a[160:163], v[20:23]
    s_waitcnt vmcnt(10)
    v_exp_f32 v78, v58
    v_mfma_f32_16x16x32_bf16 v[8:11], v[116:119], a[192:195], v[8:11]
    s_waitcnt vmcnt(9)
    v_exp_f32 v79, v59
    v_mfma_f32_16x16x32_bf16 v[8:11], v[120:123], a[232:235], v[8:11]
    s_waitcnt vmcnt(8)
    buffer_load_dwordx4 v[108:111], v0, s[12:15], s22 offen offset:1024 sc1
    v_fma_f32 v78, v78, s28, s28
    v_mfma_f32_16x16x32_bf16 v[8:11], v[124:127], v[156:159], v[8:11]
    v_rcp_f32 v86, v86
    v_mfma_f32_16x16x32_bf16 v[12:15], v[116:119], a[196:199], v[12:15]
    v_rcp_f32 v87, v87
    v_mfma_f32_16x16x32_bf16 v[12:15], v[120:123], a[236:239], v[12:15]
    v_fma_f32 v79, v79, s28, s28
    v_fmac_f32 v65, s56, v53
    v_mfma_f32_16x16x32_bf16 v[12:15], v[124:127], v[160:163], v[12:15]
    s_waitcnt lgkmcnt(0)
    buffer_load_dwordx4 v[112:115], v0, s[12:15], s22 offen offset:2048 sc1
    v_fmac_f32 v66, s56, v54
    v_mfma_f32_16x16x32_bf16 v[16:19], v[116:119], v[48:51], v[16:19]
    ds_read_b128 v[48:51], v5 offset:60928
    v_add_u32 v4, s27, v4
    v_mfma_f32_16x16x32_bf16 v[16:19], v[120:123], v[68:71], v[16:19]
    v_rcp_f32 v78, v78
    v_mfma_f32_16x16x32_bf16 v[16:19], v[124:127], v[164:167], v[16:19]
    v_rcp_f32 v79, v79
    v_mfma_f32_16x16x32_bf16 v[20:23], v[116:119], a[200:203], v[20:23]
    buffer_load_dwordx4 v[116:119], v0, s[12:15], s22 offen offset:3072 sc1
    v_fmac_f32 v67, s56, v55
    v_mfma_f32_16x16x32_bf16 v[20:23], v[120:123], v[44:47], v[20:23]
    s_add_u32 s22, s22, 4096
    ds_read_b128 v[52:55], v3 offset:3072
    v_mul_f32 v56, v56, v86
    v_mfma_f32_16x16x32_bf16 v[20:23], v[124:127], v[168:171], v[20:23]
    s_waitcnt vmcnt(10)
    v_mul_f32 v57, v57, v87
    v_mul_f32 v58, v58, v78
    v_mfma_f32_16x16x32_bf16 v[8:11], v[128:131], v[200:203], v[8:11]
    s_waitcnt vmcnt(9)
    v_mul_f32 v59, v59, v79
    v_cvt_pk_bf16_f32 v84, v56, v57
    v_mfma_f32_16x16x32_bf16 v[8:11], v[132:135], v[244:247], v[8:11]
    s_waitcnt vmcnt(8)
    buffer_load_dwordx4 v[120:123], v0, s[12:15], s22 offen offset:0 sc1
    v_cvt_pk_bf16_f32 v85, v58, v59
    v_mfma_f32_16x16x32_bf16 v[8:11], v[136:139], v[28:31], v[8:11]
    s_waitcnt lgkmcnt(0)
    v_add_f32 v64, v64, v52
    v_add_f32 v65, v65, v53
    v_mfma_f32_16x16x32_bf16 v[12:15], v[128:131], v[48:51], v[12:15]
    s_cmp_eq_u32 s26, 15
    ds_read_b128 v[48:51], v4 offset:0
    v_add_f32 v66, v66, v54
    v_mfma_f32_16x16x32_bf16 v[12:15], v[132:135], v[248:251], v[12:15]
    v_exp_f32 v74, v64
    v_mfma_f32_16x16x32_bf16 v[12:15], v[136:139], v[32:35], v[12:15]
    buffer_load_dwordx4 v[124:127], v0, s[12:15], s22 offen offset:1024 sc1
    v_add_f32 v67, v67, v55
    v_mfma_f32_16x16x32_bf16 v[16:19], v[128:131], v[204:207], v[16:19]
    v_exp_f32 v75, v65
    v_mfma_f32_16x16x32_bf16 v[16:19], v[132:135], v[252:255], v[16:19]
    ds_write_b128 v2, v[8:11] offset:33792
    v_mfma_f32_16x16x32_bf16 v[16:19], v[136:139], v[36:39], v[16:19]
    v_exp_f32 v82, v66
    v_mfma_f32_16x16x32_bf16 v[20:23], v[128:131], v[208:211], v[20:23]
    buffer_load_dwordx4 v[128:131], v0, s[12:15], s22 offen offset:2048 sc1
    v_fma_f32 v74, v74, s28, s28
    v_mfma_f32_16x16x32_bf16 v[20:23], v[132:135], v[24:27], v[20:23]
    v_exp_f32 v83, v67
    v_mfma_f32_16x16x32_bf16 v[20:23], v[136:139], v[40:43], v[20:23]
    s_waitcnt vmcnt(10) lgkmcnt(1)
    ds_write_b128 v2, v[12:15] offset:41984
    s_cbranch_scc1 TAIL
    v_mfma_f32_16x16x32_bf16 v[8:11], v[88:91], a[0:3], v[48:51]
    s_waitcnt vmcnt(9)
    v_rcp_f32 v74, v74
    v_mfma_f32_16x16x32_bf16 v[8:11], v[92:95], a[4:7], v[8:11]
    s_waitcnt vmcnt(8)
    buffer_load_dwordx4 v[132:135], v0, s[12:15], s22 offen offset:3072 sc1
    v_fma_f32 v75, v75, s28, s28
    v_mfma_f32_16x16x32_bf16 v[8:11], v[96:99], a[32:35], v[8:11]
    s_add_u32 s22, s22, 4096
    v_rcp_f32 v75, v75
    v_mfma_f32_16x16x32_bf16 v[12:15], v[88:91], a[8:11], v[48:51]
    ds_write_b128 v2, v[16:19] offset:50176
    v_mfma_f32_16x16x32_bf16 v[12:15], v[92:95], a[12:15], v[12:15]
    v_fma_f32 v82, v82, s28, s28
    v_fma_f32 v83, v83, s28, s28
    v_mfma_f32_16x16x32_bf16 v[12:15], v[96:99], a[40:43], v[12:15]
    buffer_load_dwordx4 v[136:139], v0, s[12:15], s22 offen offset:0 sc1
    v_mfma_f32_16x16x32_bf16 v[16:19], v[88:91], a[16:19], v[48:51]
    v_rcp_f32 v82, v82
    v_mfma_f32_16x16x32_bf16 v[16:19], v[92:95], a[20:23], v[16:19]
    ds_write_b128 v2, v[20:23] offset:58368
    v_mfma_f32_16x16x32_bf16 v[16:19], v[96:99], a[48:51], v[16:19]
    v_rcp_f32 v83, v83
    v_mfma_f32_16x16x32_bf16 v[20:23], v[88:91], a[24:27], v[48:51]
    buffer_load_dwordx4 v[140:143], v0, s[12:15], s22 offen offset:1024 sc1
    v_mfma_f32_16x16x32_bf16 v[20:23], v[92:95], a[28:31], v[20:23]
    ds_read_b128 v[48:51], v5 offset:26112
    v_mfma_f32_16x16x32_bf16 v[20:23], v[96:99], a[56:59], v[20:23]
    s_waitcnt vmcnt(10) lgkmcnt(1)
    s_barrier
    v_mfma_f32_16x16x32_bf16 v[8:11], v[100:103], a[36:39], v[8:11]
    s_waitcnt vmcnt(9)
    ds_read_b128 v[56:59], v3 offset:34816
    ds_read_b128 v[52:55], v3 offset:32768
    v_mfma_f32_16x16x32_bf16 v[8:11], v[104:107], a[76:79], v[8:11]
    s_waitcnt vmcnt(8)
    buffer_load_dwordx4 v[88:91], v0, s[12:15], s22 offen offset:2048 sc1
    ds_read_b128 v[60:63], v3 offset:36864
    v_mfma_f32_16x16x32_bf16 v[8:11], v[108:111], a[80:83], v[8:11]
    v_mul_f32 v64, v64, v74
    v_mul_f32 v65, v65, v75
    v_mfma_f32_16x16x32_bf16 v[12:15], v[100:103], a[44:47], v[12:15]
    v_mul_f32 v66, v66, v82
    v_mul_f32 v67, v67, v83
    v_mfma_f32_16x16x32_bf16 v[12:15], v[104:107], a[84:87], v[12:15]
    v_cvt_pk_bf16_f32 v72, v64, v65
    v_cvt_pk_bf16_f32 v73, v66, v67
    v_mfma_f32_16x16x32_bf16 v[12:15], v[108:111], a[88:91], v[12:15]
    buffer_load_dwordx4 v[92:95], v0, s[12:15], s22 offen offset:3072 sc1
    ds_read_b128 v[64:67], v3 offset:38912
    v_mfma_f32_16x16x32_bf16 v[16:19], v[100:103], a[52:55], v[16:19]
    s_waitcnt lgkmcnt(2)
    v_add_f32 v52, v52, v56
    v_add_f32 v53, v53, v57
    v_mfma_f32_16x16x32_bf16 v[16:19], v[104:107], v[48:51], v[16:19]
    s_add_u32 s22, s22, 4096
    v_add_f32 v54, v54, v58
    v_add_f32 v55, v55, v59
    v_mfma_f32_16x16x32_bf16 v[16:19], v[108:111], a[92:95], v[16:19]
    ds_read_b128 v[48:51], v5 offset:30464
    v_fma_f32 v56, -2.0, v56, v52
    v_mfma_f32_16x16x32_bf16 v[20:23], v[100:103], a[60:63], v[20:23]
    buffer_load_dwordx4 v[96:99], v0, s[12:15], s22 offen offset:0 sc1
    v_fma_f32 v57, -2.0, v57, v53
    v_mfma_f32_16x16x32_bf16 v[20:23], v[104:107], a[96:99], v[20:23]
    v_fma_f32 v58, -2.0, v58, v54
    v_fma_f32 v59, -2.0, v59, v55
    v_mfma_f32_16x16x32_bf16 v[20:23], v[108:111], a[100:103], v[20:23]
    s_waitcnt vmcnt(10) lgkmcnt(1)
    v_sub_f32 v60, v60, v64
    v_sub_f32 v61, v61, v65
    v_mfma_f32_16x16x32_bf16 v[8:11], v[112:115], a[116:119], v[8:11]
    s_waitcnt vmcnt(9)
    v_sub_f32 v62, v62, v66
    v_sub_f32 v63, v63, v67
    v_mfma_f32_16x16x32_bf16 v[8:11], v[116:119], a[120:123], v[8:11]
    s_waitcnt vmcnt(8)
    buffer_load_dwordx4 v[100:103], v0, s[12:15], s22 offen offset:1024 sc1
    v_fmac_f32 v56, s54, v60
    v_mfma_f32_16x16x32_bf16 v[8:11], v[120:123], a[164:167], v[8:11]
    v_exp_f32 v78, v56
    v_mfma_f32_16x16x32_bf16 v[12:15], v[112:115], a[124:127], v[12:15]
    v_fmac_f32 v57, s54, v61
    v_fmac_f32 v58, s54, v62
    v_mfma_f32_16x16x32_bf16 v[12:15], v[116:119], a[128:131], v[12:15]
    s_waitcnt lgkmcnt(0)
    v_fmac_f32 v59, s54, v63
    v_fma_f32 v64, 2.0, v64, v60
    v_mfma_f32_16x16x32_bf16 v[12:15], v[120:123], v[48:51], v[12:15]
    buffer_load_dwordx4 v[104:107], v0, s[12:15], s22 offen offset:2048 sc1
    v_fma_f32 v65, 2.0, v65, v61
    v_mfma_f32_16x16x32_bf16 v[16:19], v[112:115], a[132:135], v[16:19]
    v_exp_f32 v79, v57
    v_mfma_f32_16x16x32_bf16 v[16:19], v[116:119], a[136:139], v[16:19]
    ds_read_b128 v[48:51], v5 offset:34816
    v_fma_f32 v66, 2.0, v66, v62
    v_mfma_f32_16x16x32_bf16 v[16:19], v[120:123], a[176:179], v[16:19]
    v_exp_f32 v86, v58
    v_mfma_f32_16x16x32_bf16 v[20:23], v[112:115], a[140:143], v[20:23]
    buffer_load_dwordx4 v[108:111], v0, s[12:15], s22 offen offset:3072 sc1
    v_fma_f32 v67, 2.0, v67, v63
    v_mfma_f32_16x16x32_bf16 v[20:23], v[116:119], a[144:147], v[20:23]
    s_add_u32 s22, s22, 4096
    v_exp_f32 v87, v59
    v_mfma_f32_16x16x32_bf16 v[20:23], v[120:123], a[184:187], v[20:23]
    s_waitcnt vmcnt(10)
    v_fmac_f32 v60, s52, v56
    v_fmac_f32 v61, s52, v57
    v_mfma_f32_16x16x32_bf16 v[8:11], v[124:127], a[168:171], v[8:11]
    s_waitcnt vmcnt(9)
    v_fmac_f32 v62, s52, v58
    v_fmac_f32 v63, s52, v59
    v_mfma_f32_16x16x32_bf16 v[8:11], v[128:131], a[204:207], v[8:11]
    s_waitcnt vmcnt(8)
    buffer_load_dwordx4 v[112:115], v0, s[12:15], s22 offen offset:0 sc1
    v_fmac_f32 v64, s57, v52
    v_mfma_f32_16x16x32_bf16 v[8:11], v[132:135], a[208:211], v[8:11]
    v_fmac_f32 v65, s57, v53
    v_fmac_f32 v66, s57, v54
    v_mfma_f32_16x16x32_bf16 v[12:15], v[124:127], a[172:175], v[12:15]
    s_waitcnt lgkmcnt(0)
    v_fmac_f32 v67, s57, v55
    v_fma_f32 v78, v78, s28, s28
    v_mfma_f32_16x16x32_bf16 v[12:15], v[128:131], v[48:51], v[12:15]
    ds_read_b128 v[48:51], v6 offset:39168
    v_fmac_f32 v52, s55, v64
    v_mfma_f32_16x16x32_bf16 v[12:15], v[132:135], a[212:215], v[12:15]
    buffer_load_dwordx4 v[116:119], v0, s[12:15], s22 offen offset:1024 sc1
    v_fma_f32 v79, v79, s28, s28
    v_mfma_f32_16x16x32_bf16 v[16:19], v[124:127], a[180:183], v[16:19]
    v_rcp_f32 v78, v78
    v_mfma_f32_16x16x32_bf16 v[16:19], v[128:131], a[216:219], v[16:19]
    v_rcp_f32 v79, v79
    v_mfma_f32_16x16x32_bf16 v[16:19], v[132:135], a[220:223], v[16:19]
    v_fmac_f32 v53, s55, v65
    v_fma_f32 v86, v86, s28, s28
    v_mfma_f32_16x16x32_bf16 v[20:23], v[124:127], a[188:191], v[20:23]
    buffer_load_dwordx4 v[120:123], v0, s[12:15], s22 offen offset:2048 sc1
    v_fmac_f32 v54, s55, v66
    v_mfma_f32_16x16x32_bf16 v[20:23], v[128:131], a[224:227], v[20:23]
    v_fma_f32 v87, v87, s28, s28
    v_fmac_f32 v55, s55, v67
    v_mfma_f32_16x16x32_bf16 v[20:23], v[132:135], a[228:231], v[20:23]
    s_waitcnt vmcnt(10)
    v_rcp_f32 v86, v86
    v_mfma_f32_16x16x32_bf16 v[8:11], v[136:139], a[240:243], v[8:11]
    s_waitcnt vmcnt(9) lgkmcnt(0)
    v_rcp_f32 v87, v87
    v_mfma_f32_16x16x32_bf16 v[8:11], v[140:143], v[48:51], v[8:11]
    s_waitcnt vmcnt(8)
    buffer_load_dwordx4 v[124:127], v0, s[12:15], s22 offen offset:3072 sc1
    v_mul_f32 v56, v56, v78
    v_mfma_f32_16x16x32_bf16 v[8:11], v[88:91], v[172:175], v[8:11]
    s_add_u32 s22, s22, 4096
    v_exp_f32 v82, v64
    v_mfma_f32_16x16x32_bf16 v[12:15], v[136:139], a[244:247], v[12:15]
    ds_read_b128 v[48:51], v6 offset:43520
    v_mul_f32 v57, v57, v79
    v_mfma_f32_16x16x32_bf16 v[12:15], v[140:143], a[248:251], v[12:15]
    v_exp_f32 v83, v65
    v_mfma_f32_16x16x32_bf16 v[12:15], v[88:91], v[176:179], v[12:15]
    buffer_load_dwordx4 v[128:131], v0, s[12:15], s22 offen offset:0 sc1
    v_mul_f32 v58, v58, v86
    v_mfma_f32_16x16x32_bf16 v[16:19], v[136:139], a[252:255], v[16:19]
    v_exp_f32 v74, v66
    v_mfma_f32_16x16x32_bf16 v[16:19], v[140:143], v[144:147], v[16:19]
    v_exp_f32 v75, v67
    v_mfma_f32_16x16x32_bf16 v[16:19], v[88:91], v[184:187], v[16:19]
    v_mul_f32 v59, v59, v87
    v_cvt_pk_bf16_f32 v78, v56, v57
    v_mfma_f32_16x16x32_bf16 v[20:23], v[136:139], v[148:151], v[20:23]
    buffer_load_dwordx4 v[132:135], v0, s[12:15], s22 offen offset:1024 sc1
    v_cvt_pk_bf16_f32 v79, v58, v59
    v_mfma_f32_16x16x32_bf16 v[20:23], v[140:143], v[152:155], v[20:23]
    buffer_store_dwordx4 v[76:79], v1, s[8:11], s24 offen offset:1152 nt
    v_fma_f32 v82, v82, s28, s28
    v_fma_f32 v83, v83, s28, s28
    v_mfma_f32_16x16x32_bf16 v[20:23], v[88:91], v[192:195], v[20:23]
    s_waitcnt vmcnt(11) lgkmcnt(0)
    ds_read_b128 v[56:59], v3 offset:37888
    v_fma_f32 v74, v74, s28, s28
    v_mfma_f32_16x16x32_bf16 v[8:11], v[92:95], v[48:51], v[8:11]
    s_waitcnt vmcnt(10)
    v_rcp_f32 v82, v82
    v_mfma_f32_16x16x32_bf16 v[8:11], v[96:99], v[212:215], v[8:11]
    s_waitcnt vmcnt(9)
    buffer_load_dwordx4 v[136:139], v0, s[12:15], s22 offen offset:2048 sc1
    v_fma_f32 v75, v75, s28, s28
    v_mul_f32 v64, v64, v82
    v_mfma_f32_16x16x32_bf16 v[8:11], v[100:103], v[216:219], v[8:11]
    v_rcp_f32 v83, v83
    v_mfma_f32_16x16x32_bf16 v[12:15], v[92:95], v[180:183], v[12:15]
    s_waitcnt lgkmcnt(0)
    ds_read_b128 v[48:51], v5 offset:47872
    v_fmac_f32 v56, s53, v60
    v_mfma_f32_16x16x32_bf16 v[12:15], v[96:99], v[220:223], v[12:15]
    v_rcp_f32 v74, v74
    v_mfma_f32_16x16x32_bf16 v[12:15], v[100:103], v[224:227], v[12:15]
    buffer_load_dwordx4 v[88:91], v0, s[12:15], s22 offen offset:3072 sc1
    v_fmac_f32 v57, s53, v61
    v_fmac_f32 v58, s53, v62
    v_mfma_f32_16x16x32_bf16 v[16:19], v[92:95], v[188:191], v[16:19]
    s_add_u32 s22, s22, 4096
    v_rcp_f32 v75, v75
    v_mfma_f32_16x16x32_bf16 v[16:19], v[96:99], v[228:231], v[16:19]
    v_fmac_f32 v59, s53, v63
    v_mul_f32 v65, v65, v83
    v_mfma_f32_16x16x32_bf16 v[16:19], v[100:103], v[232:235], v[16:19]
    ds_write_b128 v2, v[8:11] offset:0
    v_mfma_f32_16x16x32_bf16 v[20:23], v[92:95], v[196:199], v[20:23]
    buffer_load_dwordx4 v[92:95], v0, s[12:15], s22 offen offset:0 sc1
    ds_read_b128 v[60:63], v3 offset:39936
    v_mfma_f32_16x16x32_bf16 v[20:23], v[96:99], v[236:239], v[20:23]
    v_mul_f32 v66, v66, v74
    v_mul_f32 v67, v67, v75
    v_mfma_f32_16x16x32_bf16 v[20:23], v[100:103], v[240:243], v[20:23]
    s_waitcnt vmcnt(11) lgkmcnt(2)
    v_cvt_pk_bf16_f32 v82, v64, v65
    v_cvt_pk_bf16_f32 v83, v66, v67
    v_mfma_f32_16x16x32_bf16 v[8:11], v[104:107], v[48:51], 0
    s_waitcnt vmcnt(10)
    ds_write_b128 v2, v[12:15] offset:8192
    v_mfma_f32_16x16x32_bf16 v[8:11], v[108:111], a[104:107], v[8:11]
    s_waitcnt vmcnt(9)
    buffer_load_dwordx4 v[96:99], v0, s[12:15], s22 offen offset:1024 sc1
    ds_read_b128 v[64:67], v3 offset:33792
    v_mfma_f32_16x16x32_bf16 v[8:11], v[112:115], a[148:151], v[8:11]
    s_waitcnt lgkmcnt(2)
    ds_read_b128 v[48:51], v5 offset:52224
    v_add_f32 v56, v56, v60
    v_mfma_f32_16x16x32_bf16 v[12:15], v[104:107], a[64:67], 0
    buffer_store_dwordx4 v[80:83], v1, s[8:11], s24 offen offset:2304 nt
    v_exp_f32 v86, v56
    v_mfma_f32_16x16x32_bf16 v[12:15], v[108:111], a[108:111], v[12:15]
    ds_write_b128 v2, v[16:19] offset:16384
    v_mfma_f32_16x16x32_bf16 v[12:15], v[112:115], a[152:155], v[12:15]
    buffer_load_dwordx4 v[100:103], v0, s[12:15], s22 offen offset:2048 sc1
    v_add_f32 v57, v57, v61
    v_mfma_f32_16x16x32_bf16 v[16:19], v[104:107], a[68:71], 0
    v_exp_f32 v87, v57
    v_mfma_f32_16x16x32_bf16 v[16:19], v[108:111], a[112:115], v[16:19]
    ds_write_b128 v2, v[20:23] offset:24576
    v_mfma_f32_16x16x32_bf16 v[16:19], v[112:115], a[156:159], v[16:19]
    v_add_f32 v58, v58, v62
    v_add_f32 v59, v59, v63
    v_mfma_f32_16x16x32_bf16 v[20:23], v[104:107], a[72:75], 0
    s_waitcnt lgkmcnt(2)
    buffer_load_dwordx4 v[104:107], v0, s[12:15], s22 offen offset:3072 sc1
    v_fma_f32 v86, v86, s28, s28
    v_mfma_f32_16x16x32_bf16 v[20:23], v[108:111], v[48:51], v[20:23]
    s_add_u32 s22, s22, 4096
    ds_read_b128 v[48:51], v5 offset:56576
    v_fma_f32 v87, v87, s28, s28
    v_mfma_f32_16x16x32_bf16 v[20:23], v[112:115], a[160:163], v[20:23]
    s_waitcnt vmcnt(12)
    v_exp_f32 v78, v58
    v_mfma_f32_16x16x32_bf16 v[8:11], v[116:119], a[192:195], v[8:11]
    s_waitcnt vmcnt(11)
    v_exp_f32 v79, v59
    v_mfma_f32_16x16x32_bf16 v[8:11], v[120:123], a[232:235], v[8:11]
    s_waitcnt vmcnt(10)
    buffer_load_dwordx4 v[108:111], v0, s[12:15], s22 offen offset:0 sc1
    v_fma_f32 v78, v78, s28, s28
    v_mfma_f32_16x16x32_bf16 v[8:11], v[124:127], v[156:159], v[8:11]
    v_fma_f32 v79, v79, s28, s28
    v_fmac_f32 v64, s56, v52
    v_mfma_f32_16x16x32_bf16 v[12:15], v[116:119], a[196:199], v[12:15]
    v_rcp_f32 v86, v86
    v_mfma_f32_16x16x32_bf16 v[12:15], v[120:123], a[236:239], v[12:15]
    v_rcp_f32 v87, v87
    v_mfma_f32_16x16x32_bf16 v[12:15], v[124:127], v[160:163], v[12:15]
    s_waitcnt lgkmcnt(0)
    buffer_load_dwordx4 v[112:115], v0, s[12:15], s22 offen offset:1024 sc1
    v_fmac_f32 v65, s56, v53
    v_mfma_f32_16x16x32_bf16 v[16:19], v[116:119], v[48:51], v[16:19]
    ds_read_b128 v[48:51], v5 offset:60928
    v_fmac_f32 v66, s56, v54
    v_mfma_f32_16x16x32_bf16 v[16:19], v[120:123], v[68:71], v[16:19]
    v_fmac_f32 v67, s56, v55
    v_mul_f32 v56, v56, v86
    v_mfma_f32_16x16x32_bf16 v[16:19], v[124:127], v[164:167], v[16:19]
    ds_read_b128 v[52:55], v3 offset:35840
    v_mul_f32 v57, v57, v87
    v_mfma_f32_16x16x32_bf16 v[20:23], v[116:119], a[200:203], v[20:23]
    buffer_load_dwordx4 v[116:119], v0, s[12:15], s22 offen offset:2048 sc1
    v_cvt_pk_bf16_f32 v86, v56, v57
    v_mfma_f32_16x16x32_bf16 v[20:23], v[120:123], v[44:47], v[20:23]
    v_rcp_f32 v78, v78
    v_mfma_f32_16x16x32_bf16 v[20:23], v[124:127], v[168:171], v[20:23]
    s_waitcnt vmcnt(12)
    v_rcp_f32 v79, v79
    v_mfma_f32_16x16x32_bf16 v[8:11], v[128:131], v[200:203], v[8:11]
    s_waitcnt vmcnt(11)
    v_mul_f32 v58, v58, v78
    v_mul_f32 v59, v59, v79
    v_mfma_f32_16x16x32_bf16 v[8:11], v[132:135], v[244:247], v[8:11]
    s_waitcnt vmcnt(9)
    buffer_load_dwordx4 v[120:123], v0, s[12:15], s22 offen offset:3072 sc1
    v_cvt_pk_bf16_f32 v87, v58, v59
    v_mfma_f32_16x16x32_bf16 v[8:11], v[136:139], v[28:31], v[8:11]
    s_waitcnt lgkmcnt(0)
    buffer_store_dwordx4 v[84:87], v1, s[8:11], s24 offen offset:3456 nt
    v_add_f32 v64, v64, v52
    v_add_f32 v65, v65, v53
    v_mfma_f32_16x16x32_bf16 v[12:15], v[128:131], v[48:51], v[12:15]
    s_add_u32 s22, s22, 4096
    ds_read_b128 v[48:51], v4 offset:16
    v_add_f32 v66, v66, v54
    v_mfma_f32_16x16x32_bf16 v[12:15], v[132:135], v[248:251], v[12:15]
    v_exp_f32 v74, v64
    v_mfma_f32_16x16x32_bf16 v[12:15], v[136:139], v[32:35], v[12:15]
    buffer_load_dwordx4 v[124:127], v0, s[12:15], s22 offen offset:0 sc1
    v_add_f32 v67, v67, v55
    v_mfma_f32_16x16x32_bf16 v[16:19], v[128:131], v[204:207], v[16:19]
    v_exp_f32 v75, v65
    v_mfma_f32_16x16x32_bf16 v[16:19], v[132:135], v[252:255], v[16:19]
    ds_write_b128 v2, v[8:11] offset:1024
    v_mfma_f32_16x16x32_bf16 v[16:19], v[136:139], v[36:39], v[16:19]
    v_exp_f32 v82, v66
    v_mfma_f32_16x16x32_bf16 v[20:23], v[128:131], v[208:211], v[20:23]
    buffer_load_dwordx4 v[128:131], v0, s[12:15], s22 offen offset:1024 sc1
    v_fma_f32 v74, v74, s28, s28
    v_mfma_f32_16x16x32_bf16 v[20:23], v[132:135], v[24:27], v[20:23]
    v_exp_f32 v83, v67
    v_mfma_f32_16x16x32_bf16 v[20:23], v[136:139], v[40:43], v[20:23]
    s_waitcnt vmcnt(12) lgkmcnt(1)
    ds_write_b128 v2, v[12:15] offset:9216
    s_branch LOOP
TAIL:
    s_mov_b32 s44, 1053294592
    s_mov_b32 s45, 1069547520
    s_mov_b32 s46, 1070386381
    s_mov_b32 s47, 1055100473
    s_barrier
    ds_read_b128 v[144:147], v3 offset:32768
    ds_read_b128 v[148:151], v3 offset:34816
    ds_read_b128 v[152:155], v3 offset:36864
    ds_read_b128 v[156:159], v3 offset:38912
    v_rcp_f32 v74, v74
    v_fma_f32 v75, v75, s28, s28
    v_rcp_f32 v75, v75
    v_fma_f32 v82, v82, s28, s28
    ds_write_b128 v2, v[16:19] offset:50176
    ds_write_b128 v2, v[20:23] offset:58368
    v_fma_f32 v83, v83, s28, s28
    v_rcp_f32 v82, v82
    v_rcp_f32 v83, v83
    v_mul_f32 v64, v64, v74
    v_mul_f32 v65, v65, v75
    v_mul_f32 v66, v66, v82
    v_mul_f32 v67, v67, v83
    v_cvt_pk_bf16_f32 v72, v64, v65
    v_cvt_pk_bf16_f32 v73, v66, v67
    s_waitcnt lgkmcnt(4)
    v_pk_add_f32 v[176:177], v[144:145], v[148:149] op_sel:[0,0] op_sel_hi:[1,1] neg_lo:[0,1] neg_hi:[0,1]
    v_pk_add_f32 v[178:179], v[146:147], v[150:151] op_sel:[0,0] op_sel_hi:[1,1] neg_lo:[0,1] neg_hi:[0,1]
    s_waitcnt lgkmcnt(2)
    v_pk_add_f32 v[180:181], v[152:153], v[156:157] op_sel:[0,0] op_sel_hi:[1,1] neg_lo:[0,1] neg_hi:[0,1]
    v_pk_add_f32 v[182:183], v[154:155], v[158:159] op_sel:[0,0] op_sel_hi:[1,1] neg_lo:[0,1] neg_hi:[0,1]
    v_pk_fma_f32 v[184:185], s[54:55], v[180:181], v[176:177] op_sel:[0,0,0] op_sel_hi:[0,1,1]
    v_pk_fma_f32 v[186:187], s[54:55], v[182:183], v[178:179] op_sel:[0,0,0] op_sel_hi:[0,1,1]
    v_exp_f32 v188, v184
    v_exp_f32 v189, v185
    v_exp_f32 v190, v186
    v_exp_f32 v191, v187
    v_pk_fma_f32 v[188:189], v[188:189], s[28:29], s[28:29] op_sel:[0,0,0] op_sel_hi:[1,0,0]
    v_pk_fma_f32 v[190:191], v[190:191], s[28:29], s[28:29] op_sel:[0,0,0] op_sel_hi:[1,0,0]
    v_rcp_f32 v188, v188
    v_rcp_f32 v189, v189
    v_rcp_f32 v190, v190
    v_rcp_f32 v191, v191
    s_waitcnt lgkmcnt(0)
    s_barrier
    ds_read_b128 v[168:171], v3 offset:37888
    ds_read_b128 v[172:175], v3 offset:39936
    ds_read_b128 v[160:163], v3 offset:33792
    ds_read_b128 v[164:167], v3 offset:35840
    v_pk_mul_f32 v[184:185], v[184:185], v[188:189] op_sel:[0,0] op_sel_hi:[1,1]
    v_pk_mul_f32 v[186:187], v[186:187], v[190:191] op_sel:[0,0] op_sel_hi:[1,1]
    v_cvt_pk_bf16_f32 v78, v184, v185
    v_cvt_pk_bf16_f32 v79, v186, v187
    buffer_store_dwordx4 v[76:79], v1, s[8:11], s24 offen offset:1152 nt
    v_pk_add_f32 v[144:145], v[144:145], v[148:149] op_sel:[0,0] op_sel_hi:[1,1]
    v_pk_add_f32 v[146:147], v[146:147], v[150:151] op_sel:[0,0] op_sel_hi:[1,1]
    v_pk_add_f32 v[152:153], v[152:153], v[156:157] op_sel:[0,0] op_sel_hi:[1,1]
    v_pk_add_f32 v[154:155], v[154:155], v[158:159] op_sel:[0,0] op_sel_hi:[1,1]
    v_pk_fma_f32 v[184:185], s[56:57], v[144:145], v[152:153] op_sel:[1,0,0] op_sel_hi:[1,1,1]
    v_pk_fma_f32 v[186:187], s[56:57], v[146:147], v[154:155] op_sel:[1,0,0] op_sel_hi:[1,1,1]
    v_exp_f32 v188, v184
    v_exp_f32 v189, v185
    v_exp_f32 v190, v186
    v_exp_f32 v191, v187
    v_pk_fma_f32 v[188:189], v[188:189], s[28:29], s[28:29] op_sel:[0,0,0] op_sel_hi:[1,0,0]
    v_pk_fma_f32 v[190:191], v[190:191], s[28:29], s[28:29] op_sel:[0,0,0] op_sel_hi:[1,0,0]
    v_rcp_f32 v188, v188
    v_rcp_f32 v189, v189
    v_rcp_f32 v190, v190
    v_rcp_f32 v191, v191
    v_pk_mul_f32 v[184:185], v[184:185], v[188:189] op_sel:[0,0] op_sel_hi:[1,1]
    v_pk_mul_f32 v[186:187], v[186:187], v[190:191] op_sel:[0,0] op_sel_hi:[1,1]
    v_cvt_pk_bf16_f32 v82, v184, v185
    v_cvt_pk_bf16_f32 v83, v186, v187
    buffer_store_dwordx4 v[80:83], v1, s[8:11], s24 offen offset:2304 nt
    s_waitcnt lgkmcnt(2)
    v_pk_add_f32 v[168:169], v[168:169], v[172:173] op_sel:[0,0] op_sel_hi:[1,1]
    v_pk_add_f32 v[170:171], v[170:171], v[174:175] op_sel:[0,0] op_sel_hi:[1,1]
    v_pk_fma_f32 v[168:169], s[44:45], v[176:177], v[168:169] op_sel:[0,0,0] op_sel_hi:[0,1,1]
    v_pk_fma_f32 v[170:171], s[44:45], v[178:179], v[170:171] op_sel:[0,0,0] op_sel_hi:[0,1,1]
    v_pk_fma_f32 v[168:169], s[44:45], v[180:181], v[168:169] op_sel:[1,0,0] op_sel_hi:[1,1,1]
    v_pk_fma_f32 v[170:171], s[44:45], v[182:183], v[170:171] op_sel:[1,0,0] op_sel_hi:[1,1,1]
    v_exp_f32 v188, v168
    v_exp_f32 v189, v169
    v_exp_f32 v190, v170
    v_exp_f32 v191, v171
    v_pk_fma_f32 v[188:189], v[188:189], s[28:29], s[28:29] op_sel:[0,0,0] op_sel_hi:[1,0,0]
    v_pk_fma_f32 v[190:191], v[190:191], s[28:29], s[28:29] op_sel:[0,0,0] op_sel_hi:[1,0,0]
    v_rcp_f32 v188, v188
    v_rcp_f32 v189, v189
    v_rcp_f32 v190, v190
    v_rcp_f32 v191, v191
    v_pk_mul_f32 v[168:169], v[168:169], v[188:189] op_sel:[0,0] op_sel_hi:[1,1]
    v_pk_mul_f32 v[170:171], v[170:171], v[190:191] op_sel:[0,0] op_sel_hi:[1,1]
    v_cvt_pk_bf16_f32 v86, v168, v169
    v_cvt_pk_bf16_f32 v87, v170, v171
    buffer_store_dwordx4 v[84:87], v1, s[8:11], s24 offen offset:3456 nt
    s_waitcnt lgkmcnt(0)
    v_pk_add_f32 v[160:161], v[160:161], v[164:165] op_sel:[0,0] op_sel_hi:[1,1]
    v_pk_add_f32 v[162:163], v[162:163], v[166:167] op_sel:[0,0] op_sel_hi:[1,1]
    v_pk_fma_f32 v[160:161], s[46:47], v[144:145], v[160:161] op_sel:[0,0,0] op_sel_hi:[0,1,1]
    v_pk_fma_f32 v[162:163], s[46:47], v[146:147], v[162:163] op_sel:[0,0,0] op_sel_hi:[0,1,1]
    v_pk_fma_f32 v[160:161], s[46:47], v[152:153], v[160:161] op_sel:[1,0,0] op_sel_hi:[1,1,1]
    v_pk_fma_f32 v[162:163], s[46:47], v[154:155], v[162:163] op_sel:[1,0,0] op_sel_hi:[1,1,1]
    v_exp_f32 v188, v160
    v_exp_f32 v189, v161
    v_exp_f32 v190, v162
    v_exp_f32 v191, v163
    v_pk_fma_f32 v[188:189], v[188:189], s[28:29], s[28:29] op_sel:[0,0,0] op_sel_hi:[1,0,0]
    v_pk_fma_f32 v[190:191], v[190:191], s[28:29], s[28:29] op_sel:[0,0,0] op_sel_hi:[1,0,0]
    v_rcp_f32 v188, v188
    v_rcp_f32 v189, v189
    v_rcp_f32 v190, v190
    v_rcp_f32 v191, v191
    v_pk_mul_f32 v[160:161], v[160:161], v[188:189] op_sel:[0,0] op_sel_hi:[1,1]
    v_pk_mul_f32 v[162:163], v[162:163], v[190:191] op_sel:[0,0] op_sel_hi:[1,1]
    v_cvt_pk_bf16_f32 v74, v160, v161
    v_cvt_pk_bf16_f32 v75, v162, v163
    buffer_store_dwordx4 v[72:75], v1, s[8:11], s24 offen offset:0 nt
MAIN_END:
    s_endpgm
SPINA:
    s_sub_u32 s35, s35, 1
    s_cbranch_scc1 GOA
    buffer_load_dwordx2 v[44:45], v48, s[16:19], 0 offen sc1
    s_waitcnt vmcnt(0)
    v_cmp_ne_u64 vcc, s[36:37], v[44:45]
    s_nop 1
    s_and_b64 vcc, vcc, s[42:43]
    s_cbranch_scc1 SPINA
    s_branch GOA
SPINB:
    s_sub_u32 s35, s35, 1
    s_cbranch_scc1 GOB
    buffer_load_dwordx2 v[72:73], v87, s[16:19], 0 offen sc1
    s_waitcnt vmcnt(0)
    v_cmp_ne_u64 vcc, s[36:37], v[72:73]
    s_nop 1
    s_and_b64 vcc, vcc, s[96:97]
    s_cbranch_scc1 SPINB
    s_branch GOB
CODE_END:
.section .rodata,"a"
.p2align 6
.amdhsa_kernel standalone__batchnorm__sampling_kernel
  .amdhsa_next_free_vgpr 512
  .amdhsa_next_free_sgpr 102
  .amdhsa_accum_offset 256
  .amdhsa_group_segment_fixed_size 0
  .amdhsa_kernarg_size 72
  .amdhsa_user_sgpr_count 2
  .amdhsa_user_sgpr_kernarg_segment_ptr 1
  .amdhsa_system_sgpr_workgroup_id_x 1
  .amdhsa_float_denorm_mode_32 3
.end_amdhsa_kernel
```
